```python
import torch

def _softmax(x, axis=-1):
    return torch.softmax(x, dim=axis)
def _gelu(x):
    return torch.nn.functional.gelu(x, approximate="tanh")
def _silu(x):
    return torch.nn.functional.silu(x)
def _sigmoid(x):
    return torch.sigmoid(x)
def _layernorm(x, axis=-1, eps=1e-5):
    m = x.mean(dim=axis, keepdim=True)
    v = x.var(dim=axis, keepdim=True, unbiased=False)
    return (x - m) / torch.sqrt(v + eps)
def _scatter_add(tgt, idx, src, axis=0):
    return tgt.clone().index_add_(axis, idx, src)
def _segment_sum(src, seg, n):
    out = torch.zeros((n,) + src.shape[1:], dtype=src.dtype)
    return out.index_add_(0, seg, src)
def _pad(x, pw):
    flat = tuple(v for pair in reversed(pw) for v in pair)
    return torch.nn.functional.pad(x, flat)

kernel_name = 'gated_mix__sliding_local_dilated__moe_arch_mod__prompt'

def setup_inputs():

    _w = (lambda a: (lambda t: t.to(torch.bfloat16) if t.is_floating_point() else t)(torch.as_tensor(a)))
    def _A_setup():
        B, S, D = 1, 2048, 640
        return {
            "x": _w((lambda *s: torch.randn(*s, dtype=torch.bfloat16) * 0.05)(B, S, D)),
            "wqkv": _w((lambda *s: torch.randn(*s, dtype=torch.bfloat16) * 0.8)(D, 3 * D)),
            "wo": _w((lambda *s: torch.randn(*s, dtype=torch.bfloat16) * 0.05)(D, D)),
        }
    _A_in = _A_setup()

    def _B_setup():
        B, S, D, F, C = 1, 2048, 640, 1728, 1
        return {
            "x": _w((lambda *s: torch.randn(*s, dtype=torch.bfloat16) * 0.05)(B, S, D)),
            "w_r": _w((lambda *s: torch.randn(*s, dtype=torch.bfloat16) * 1.6)(D)),
            "w_gate": _w((lambda *s: torch.randn(*s, dtype=torch.bfloat16) * 0.4)(D, F)),
            "w_up": _w((lambda *s: torch.randn(*s, dtype=torch.bfloat16) * 0.4)(D, F)),
            "w_down": _w((lambda *s: torch.randn(*s, dtype=torch.bfloat16) * 0.4)(F, D)),
        }
    _B_in = _B_setup()

    return {
        "A_x": _A_in["x"],
        "A_wqkv": _A_in["wqkv"],
        "A_wo": _A_in["wo"],
        "B_x": _B_in["x"],
        "B_w_r": _B_in["w_r"],
        "B_w_gate": _B_in["w_gate"],
        "B_w_up": _B_in["w_up"],
        "B_w_down": _B_in["w_down"],
        "gate_w": _w((lambda *s: torch.randn(*s, dtype=torch.bfloat16) * 0.05)(640) * 16.0),
    }

def reference(A_x, A_wqkv, A_wo, B_x, B_w_r, B_w_gate, B_w_up, B_w_down, gate_w):
    def _A_ref(x, wqkv, wo):
        B, S, D = x.shape
        H = 32; Dh = D // H
        W, dil = 8, 2
        qkv = (lambda x, *d: x.permute(*d))((x @ wqkv).reshape(B, S, 3, H, Dh), 2, 0, 3, 1, 4)
        q, k, v = qkv[0], qkv[1], qkv[2]
        scale = Dh ** -0.5
        pos = torch.arange(S)
        off = torch.arange(W) * dil
        idx = pos[:, None] - off[None, :]
        mask = idx >= 0
        idx_c = torch.where(mask, idx, 0).reshape(-1)
        kg = k[:, :, idx_c, :].reshape(B, H, S, W, Dh)
        vg = v[:, :, idx_c, :].reshape(B, H, S, W, Dh)
        logits = torch.einsum("bhsd,bhswd->bhsw", q, kg) * scale
        logits = torch.where(mask[None, None, :, :], logits, -1e9)
        attn = _softmax(logits, axis=-1)
        o = torch.einsum("bhsw,bhswd->bhsd", attn, vg)
        return (lambda x, *d: x.permute(*d))(o, 0, 2, 1, 3).reshape(B, S, D) @ wo

    def _B_ref(x, w_r, w_gate, w_up, w_down):
        B, S, D = x.shape
        C = 1
        r = x @ w_r
        idx = torch.argsort(-r, axis=-1)[:, :C]
        idx_e = (lambda x, n, axis: torch.repeat_interleave(x, n, dim=axis))(idx.reshape(B, C, 1), D, axis=2)
        x_sel = (lambda x, i, axis: torch.take_along_dim(x, i, dim=axis))(x, idx_e, axis=1)
        g = _silu(x_sel @ w_gate)
        u = x_sel @ w_up
        y = (g * u) @ w_down
        r_sel = _sigmoid((lambda x, i, axis: torch.take_along_dim(x, i, dim=axis))(r, idx, axis=1))
        y = y * r_sel.reshape(B, C, 1)
        b_off = (torch.arange(B) * S).reshape(B, 1)
        flat_idx = (idx + b_off).reshape(B * C)
        zero = (x * 0.0).reshape(B * S, D)
        upd = _scatter_add(zero, flat_idx, y.reshape(B * C, D), axis=0)
        return x + upd.reshape(B, S, D)

    x = A_x
    g = _sigmoid((x * gate_w).sum(-1, keepdims=True))
    a = _A_ref(x, A_wqkv, A_wo)
    b = _B_ref(x, B_w_r, B_w_gate, B_w_up, B_w_down)
    return g * a + (1 - g) * b
```

```asm
; @launch grid=(256,1,1) block=(512,1,1) lds=163840
.amdgcn_target "amdgcn-amd-amdhsa--gfx950"
.text
.globl gated_mix__sliding_local_dilated__moe_arch_mod__prompt_kernel
.p2align 8
.type gated_mix__sliding_local_dilated__moe_arch_mod__prompt_kernel,@function
gated_mix__sliding_local_dilated__moe_arch_mod__prompt_kernel:
    s_cmp_lt_u32 s2, 256
    s_cbranch_scc0 L_exit
    s_getpc_b64 s[4:5]
    s_and_b32 s6, s2, 56
    s_mul_i32 s6, s6, 512
    v_min_u32 v1, 31, v0
    v_lshl_add_u32 v1, v1, 7, s6
    global_load_dword v255, v1, s[4:5]
    s_load_dwordx2 s[44:45], s[0:1], 8
    s_load_dwordx2 s[40:41], s[0:1], 0
    s_load_dwordx2 s[48:49], s[0:1], 88
    v_lshrrev_b32 v1, 6, v0
    v_and_b32 v0, 63, v0
    v_readfirstlane_b32 s28, v1
    s_and_b32 s29, s2, 7
    s_lshr_b32 s30, s2, 3
    s_and_b32 s6, s29, 1
    s_lshl_b32 s6, s6, 2
    s_and_b32 s10, s30, 3
    s_add_u32 s32, s6, s10
    s_lshr_b32 s6, s29, 1
    s_lshr_b32 s7, s30, 2
    s_mul_i32 s31, s6, 7
    s_add_u32 s31, s31, s7
    s_lshr_b32 s33, s29, 2
    s_mul_i32 s8, s33, 14
    s_sub_u32 s34, s31, s8
    s_mov_b32 s46, 2457600
    s_mov_b32 s47, 0x20000
    s_mov_b32 s42, 2621440
    s_mov_b32 s43, 0x20000
    v_mov_b32 v9, 0x80000000
    v_lshrrev_b32 v2, 3, v0
    v_mul_u32_u24 v2, 2560, v2
    v_lshrrev_b32 v3, 4, v0
    v_and_b32 v4, 7, v0
    v_xor_b32 v3, v3, v4
    v_lshl_add_u32 v2, v3, 4, v2
    s_cmp_eq_u32 s28, 7
    s_cbranch_scc1 L_aux
    s_cmp_ge_u32 s30, 28
    s_cbranch_scc1 L_spare
    s_cmp_lt_u32 s28, 4
    s_cbranch_scc1 L_compute
L_ldr:
    s_mul_i32 s7, s7, 1
    s_mul_i32 s10, s10, 0
    s_add_u32 s7, s7, s10
    s_mul_i32 s10, s29, 2
    s_add_u32 s7, s7, s10
    s_lshr_b32 s7, s7, 1
    s_mul_i32 s8, s7, 16385
    s_lshr_b32 s8, s8, 16
    s_mul_i32 s8, s8, 4
    s_sub_u32 s14, s7, s8
    s_sub_u32 s5, s28, 4
    s_mul_i32 s6, s34, 73
    s_lshl_b32 s7, s5, 3
    s_add_u32 s6, s6, s7
    s_mul_i32 s6, s6, 2560
    s_mul_i32 s7, s33, 1280
    s_add_u32 s6, s6, s7
    s_and_b32 s7, s5, 1
    s_lshl_b32 s7, s7, 6
    v_xor_b32 v2, s7, v2
    v_add_u32 v16, s6, v2
    v_xor_b32 v17, 64, v16
    v_add_u32 v18, 122880, v16
    v_add_u32 v19, 184320, v17
    v_add_u32 v17, 61440, v17
    s_lshl_b32 s19, s5, 10
    s_add_u32 s19, s19, 61440
    s_lshl_b32 s15, s14, 7
    s_mul_i32 s17, s5, 1280
    s_mul_i32 s9, s32, 160
    s_add_u32 s17, s17, s9
    s_mul_i32 s16, s14, 245760
    s_add_u32 s16, s16, s17
    s_add_u32 s20, s17, 983040
    s_mul_i32 s18, s5, 5120
    s_waitcnt lgkmcnt(0)
    s_add_u32 m0, s19, 0
    s_cmp_lg_u32 s5, 0
    buffer_load_dwordx4 v16, s[40:43], s15 offen lds
    s_cbranch_scc1 L_x4_1
    s_add_u32 m0, s19, 9216
    s_nop 0
    buffer_load_dwordx4 v19, s[40:43], s15 offen lds
L_x4_1:
    s_add_u32 m0, s19, 3072
    s_nop 0
    buffer_load_dwordx4 v17, s[40:43], s15 offen lds
    s_add_u32 m0, s19, 6144
    s_nop 0
    buffer_load_dwordx4 v18, s[40:43], s15 offen lds
    s_add_u32 s15, s15, 128
    s_cmp_eq_u32 s15, 512
    s_cselect_b32 s15, 0, s15
    s_load_dword s39, s[48:49], 0
    v_mul_u32_u24 v2, 6554, v0
    v_lshlrev_b32 v6, 4, v0
    s_mov_b32 s6, 3680
    s_mov_b32 s7, 3840
    s_mov_b32 s8, -2880
    v_lshrrev_b32 v3, 16, v2
    v_mad_u32_u24 v4, v3, s6, v6
    v_and_b32 v5, 12, v3
    v_mad_u32_u24 v10, v5, s7, v4
    v_add_u32 v2, 419456, v2
    v_add_u32 v6, 1024, v6
    v_lshrrev_b32 v3, 16, v2
    v_mad_u32_u24 v4, v3, s6, v6
    v_and_b32 v5, 12, v3
    v_mad_u32_u24 v11, v5, s7, v4
    v_add_u32 v2, 419456, v2
    v_add_u32 v6, 1024, v6
    v_lshrrev_b32 v3, 16, v2
    v_mad_u32_u24 v4, v3, s6, v6
    v_and_b32 v5, 12, v3
    v_mad_u32_u24 v12, v5, s7, v4
    v_and_b32 v5, 16, v3
    v_mad_i32_i24 v12, v5, s8, v12
    v_add_u32 v2, 419456, v2
    v_add_u32 v6, 4294922240, v6
    v_lshrrev_b32 v3, 16, v2
    v_mad_u32_u24 v4, v3, s6, v6
    v_and_b32 v5, 12, v3
    v_mad_u32_u24 v13, v5, s7, v4
    v_add_u32 v2, 419456, v2
    v_add_u32 v6, 1024, v6
    v_lshrrev_b32 v3, 16, v2
    v_mad_u32_u24 v4, v3, s6, v6
    v_and_b32 v5, 12, v3
    v_mad_u32_u24 v14, v5, s7, v4
    s_barrier
L_ldr2:
    s_add_u32 m0, s18, 0
    s_nop 0
    buffer_load_dwordx4 v10, s[44:47], s16 offen lds
    s_add_u32 m0, s18, 1024
    s_nop 0
    buffer_load_dwordx4 v11, s[44:47], s16 offen lds
    s_add_u32 m0, s18, 2048
    s_nop 0
    buffer_load_dwordx4 v12, s[44:47], s16 offen lds
    s_add_u32 m0, s18, 3072
    s_nop 0
    buffer_load_dwordx4 v13, s[44:47], s16 offen lds
    s_add_u32 m0, s18, 4096
    s_nop 0
    buffer_load_dwordx4 v14, s[44:47], s16 offen lds
    s_add_u32 s16, s16, 122880
    s_add_u32 m0, s19, 10240
    s_cmp_lg_u32 s5, 0
    buffer_load_dwordx4 v16, s[40:43], s15 offen lds
    s_cbranch_scc1 L_x4_2
    s_add_u32 m0, s19, 19456
    s_nop 0
    buffer_load_dwordx4 v19, s[40:43], s15 offen lds
L_x4_2:
    s_add_u32 m0, s19, 13312
    s_nop 0
    buffer_load_dwordx4 v17, s[40:43], s15 offen lds
    s_add_u32 m0, s19, 16384
    s_nop 0
    buffer_load_dwordx4 v18, s[40:43], s15 offen lds
    s_add_u32 s15, s15, 128
    s_cmp_eq_u32 s15, 512
    s_cselect_b32 s15, 0, s15
    s_add_u32 m0, s18, 15360
    s_nop 0
    buffer_load_dwordx4 v10, s[44:47], s16 offen lds
    s_add_u32 m0, s18, 16384
    s_nop 0
    buffer_load_dwordx4 v11, s[44:47], s16 offen lds
    s_add_u32 m0, s18, 17408
    s_nop 0
    buffer_load_dwordx4 v12, s[44:47], s16 offen lds
    s_add_u32 m0, s18, 18432
    s_nop 0
    buffer_load_dwordx4 v13, s[44:47], s16 offen lds
    s_add_u32 m0, s18, 19456
    s_nop 0
    buffer_load_dwordx4 v14, s[44:47], s16 offen lds
    s_add_u32 s16, s16, 122880
    s_cmp_eq_u32 s16, s20
    s_cselect_b32 s16, s17, s16
    s_mov_b32 s22, 7772244
    s_mov_b32 s23, 7706184
    s_bitcmp1_b32 s32, 0
    s_cselect_b32 s22, 5866614, s22
    s_cselect_b32 s23, 5735529, s23
    s_bitcmp1_b32 s32, 1
    s_cselect_b32 s22, s23, s22
    s_mov_b32 s3, 100000
    s_mov_b32 s50, 6946816
    s_mov_b32 s51, 0x20000
    s_mul_i32 s8, s30, 37
    s_lshr_b32 s8, s8, 8
    s_mul_i32 s9, s8, 7
    s_sub_u32 s37, s30, s9
    s_lshl_b32 s36, s29, 2
    s_add_u32 s36, s36, s8
    s_mul_i32 s4, s37, 96
    s_waitcnt lgkmcnt(0)
    s_mul_i32 s35, s39, 1664525
    s_add_u32 s35, s35, 1013904223
    s_waitcnt vmcnt(8)
    s_barrier
    s_add_u32 m0, s18, 30720
    s_nop 0
    buffer_load_dwordx4 v10, s[44:47], s16 offen lds
    s_add_u32 m0, s18, 31744
    s_nop 0
    buffer_load_dwordx4 v11, s[44:47], s16 offen lds
    s_add_u32 m0, s18, 32768
    s_nop 0
    buffer_load_dwordx4 v12, s[44:47], s16 offen lds
    s_add_u32 m0, s18, 33792
    s_nop 0
    buffer_load_dwordx4 v13, s[44:47], s16 offen lds
    s_add_u32 m0, s18, 34816
    s_nop 0
    buffer_load_dwordx4 v14, s[44:47], s16 offen lds
    s_add_u32 s16, s16, 122880
    s_add_u32 m0, s19, 20480
    s_cmp_lg_u32 s5, 0
    buffer_load_dwordx4 v16, s[40:43], s15 offen lds
    s_cbranch_scc1 L_x4_3
    s_add_u32 m0, s19, 29696
    s_nop 0
    buffer_load_dwordx4 v19, s[40:43], s15 offen lds
L_x4_3:
    s_add_u32 m0, s19, 23552
    s_nop 0
    buffer_load_dwordx4 v17, s[40:43], s15 offen lds
    s_add_u32 m0, s19, 26624
    s_nop 0
    buffer_load_dwordx4 v18, s[40:43], s15 offen lds
    s_add_u32 s15, s15, 128
    s_cmp_eq_u32 s15, 512
    s_cselect_b32 s15, 0, s15
    s_add_u32 m0, s18, 46080
    s_nop 0
    buffer_load_dwordx4 v10, s[44:47], s16 offen lds
    s_add_u32 m0, s18, 47104
    s_nop 0
    buffer_load_dwordx4 v11, s[44:47], s16 offen lds
    s_add_u32 m0, s18, 48128
    s_nop 0
    buffer_load_dwordx4 v12, s[44:47], s16 offen lds
    s_add_u32 m0, s18, 49152
    s_nop 0
    buffer_load_dwordx4 v13, s[44:47], s16 offen lds
    s_add_u32 m0, s18, 50176
    s_nop 0
    buffer_load_dwordx4 v14, s[44:47], s16 offen lds
    s_add_u32 s16, s16, 122880
    s_cmp_eq_u32 s16, s20
    s_cselect_b32 s16, s17, s16
    s_waitcnt vmcnt(13)
    s_barrier
    s_add_u32 m0, s19, 30720
    s_cmp_lg_u32 s5, 0
    buffer_load_dwordx4 v16, s[40:43], s15 offen lds
    s_cbranch_scc1 L_x4_4
    s_add_u32 m0, s19, 39936
    s_nop 0
    buffer_load_dwordx4 v19, s[40:43], s15 offen lds
L_x4_4:
    s_add_u32 m0, s19, 33792
    s_nop 0
    buffer_load_dwordx4 v17, s[40:43], s15 offen lds
    s_add_u32 m0, s19, 36864
    s_nop 0
    buffer_load_dwordx4 v18, s[40:43], s15 offen lds
    s_add_u32 m0, s18, 0
    s_nop 0
    buffer_load_dwordx4 v10, s[44:47], s16 offen lds
    s_add_u32 m0, s18, 1024
    s_nop 0
    buffer_load_dwordx4 v11, s[44:47], s16 offen lds
    s_add_u32 m0, s18, 2048
    s_nop 0
    buffer_load_dwordx4 v12, s[44:47], s16 offen lds
    s_add_u32 m0, s18, 3072
    s_nop 0
    buffer_load_dwordx4 v13, s[44:47], s16 offen lds
    s_add_u32 m0, s18, 4096
    s_nop 0
    buffer_load_dwordx4 v14, s[44:47], s16 offen lds
    s_add_u32 s16, s16, 122880
    s_waitcnt vmcnt(16)
    s_barrier
    s_bfe_u32 s21, s22, 0x40000
    s_mul_i32 s23, s21, 10240
    s_add_u32 s23, s23, s19
    s_lshl_b32 s21, s21, 7
    s_add_u32 m0, s23, 0
    s_cmp_lg_u32 s5, 0
    buffer_load_dwordx4 v16, s[40:43], s21 offen lds
    s_cbranch_scc1 L_x4_5
    s_add_u32 m0, s23, 9216
    s_nop 0
    buffer_load_dwordx4 v19, s[40:43], s21 offen lds
L_x4_5:
    s_add_u32 m0, s23, 3072
    s_nop 0
    buffer_load_dwordx4 v17, s[40:43], s21 offen lds
    s_add_u32 m0, s23, 6144
    s_nop 0
    buffer_load_dwordx4 v18, s[40:43], s21 offen lds
    s_bfe_u32 s21, s22, 0x40004
    s_mul_i32 s23, s21, 10240
    s_add_u32 s23, s23, s19
    s_lshl_b32 s21, s21, 7
    s_add_u32 m0, s23, 0
    s_cmp_lg_u32 s5, 0
    buffer_load_dwordx4 v16, s[40:43], s21 offen lds
    s_cbranch_scc1 L_x4_6
    s_add_u32 m0, s23, 9216
    s_nop 0
    buffer_load_dwordx4 v19, s[40:43], s21 offen lds
L_x4_6:
    s_add_u32 m0, s23, 3072
    s_nop 0
    buffer_load_dwordx4 v17, s[40:43], s21 offen lds
    s_add_u32 m0, s23, 6144
    s_nop 0
    buffer_load_dwordx4 v18, s[40:43], s21 offen lds
    s_add_u32 m0, s18, 15360
    s_nop 0
    buffer_load_dwordx4 v10, s[44:47], s16 offen lds
    s_add_u32 m0, s18, 16384
    s_nop 0
    buffer_load_dwordx4 v11, s[44:47], s16 offen lds
    s_add_u32 m0, s18, 17408
    s_nop 0
    buffer_load_dwordx4 v12, s[44:47], s16 offen lds
    s_add_u32 m0, s18, 18432
    s_nop 0
    buffer_load_dwordx4 v13, s[44:47], s16 offen lds
    s_add_u32 m0, s18, 19456
    s_nop 0
    buffer_load_dwordx4 v14, s[44:47], s16 offen lds
    s_add_u32 s16, s16, 122880
    s_cmp_eq_u32 s16, s20
    s_cselect_b32 s16, s17, s16
    s_waitcnt vmcnt(19)
    s_barrier
    s_bfe_u32 s21, s22, 0x40008
    s_mul_i32 s23, s21, 10240
    s_add_u32 s23, s23, s19
    s_lshl_b32 s21, s21, 7
    s_add_u32 m0, s23, 0
    s_cmp_lg_u32 s5, 0
    buffer_load_dwordx4 v16, s[40:43], s21 offen lds
    s_cbranch_scc1 L_x4_7
    s_add_u32 m0, s23, 9216
    s_nop 0
    buffer_load_dwordx4 v19, s[40:43], s21 offen lds
L_x4_7:
    s_add_u32 m0, s23, 3072
    s_nop 0
    buffer_load_dwordx4 v17, s[40:43], s21 offen lds
    s_add_u32 m0, s23, 6144
    s_nop 0
    buffer_load_dwordx4 v18, s[40:43], s21 offen lds
    s_add_u32 m0, s18, 30720
    s_nop 0
    buffer_load_dwordx4 v10, s[44:47], s16 offen lds
    s_add_u32 m0, s18, 31744
    s_nop 0
    buffer_load_dwordx4 v11, s[44:47], s16 offen lds
    s_add_u32 m0, s18, 32768
    s_nop 0
    buffer_load_dwordx4 v12, s[44:47], s16 offen lds
    s_add_u32 m0, s18, 33792
    s_nop 0
    buffer_load_dwordx4 v13, s[44:47], s16 offen lds
    s_add_u32 m0, s18, 34816
    s_nop 0
    buffer_load_dwordx4 v14, s[44:47], s16 offen lds
    s_add_u32 s16, s16, 122880
    s_waitcnt vmcnt(19)
    s_barrier
    s_bfe_u32 s21, s22, 0x4000c
    s_mul_i32 s23, s21, 10240
    s_add_u32 s23, s23, s19
    s_lshl_b32 s21, s21, 7
    s_add_u32 m0, s23, 0
    s_cmp_lg_u32 s5, 0
    buffer_load_dwordx4 v16, s[40:43], s21 offen lds
    s_cbranch_scc1 L_x4_8
    s_add_u32 m0, s23, 9216
    s_nop 0
    buffer_load_dwordx4 v19, s[40:43], s21 offen lds
L_x4_8:
    s_add_u32 m0, s23, 3072
    s_nop 0
    buffer_load_dwordx4 v17, s[40:43], s21 offen lds
    s_add_u32 m0, s23, 6144
    s_nop 0
    buffer_load_dwordx4 v18, s[40:43], s21 offen lds
    s_add_u32 m0, s18, 46080
    s_nop 0
    buffer_load_dwordx4 v10, s[44:47], s16 offen lds
    s_add_u32 m0, s18, 47104
    s_nop 0
    buffer_load_dwordx4 v11, s[44:47], s16 offen lds
    s_add_u32 m0, s18, 48128
    s_nop 0
    buffer_load_dwordx4 v12, s[44:47], s16 offen lds
    s_add_u32 m0, s18, 49152
    s_nop 0
    buffer_load_dwordx4 v13, s[44:47], s16 offen lds
    s_add_u32 m0, s18, 50176
    s_nop 0
    buffer_load_dwordx4 v14, s[44:47], s16 offen lds
    s_add_u32 s16, s16, 122880
    s_cmp_eq_u32 s16, s20
    s_cselect_b32 s16, s17, s16
    s_waitcnt vmcnt(16)
    s_barrier
    s_bfe_u32 s21, s22, 0x40010
    s_mul_i32 s23, s21, 10240
    s_add_u32 s23, s23, s19
    s_lshl_b32 s21, s21, 7
    s_add_u32 m0, s23, 0
    s_cmp_lg_u32 s5, 0
    buffer_load_dwordx4 v16, s[40:43], s21 offen lds
    s_cbranch_scc1 L_x4_9
    s_add_u32 m0, s23, 9216
    s_nop 0
    buffer_load_dwordx4 v19, s[40:43], s21 offen lds
L_x4_9:
    s_add_u32 m0, s23, 3072
    s_nop 0
    buffer_load_dwordx4 v17, s[40:43], s21 offen lds
    s_add_u32 m0, s23, 6144
    s_nop 0
    buffer_load_dwordx4 v18, s[40:43], s21 offen lds
    s_bfe_u32 s21, s22, 0x40014
    s_mul_i32 s23, s21, 10240
    s_add_u32 s23, s23, s19
    s_lshl_b32 s21, s21, 7
    s_add_u32 m0, s23, 0
    s_cmp_lg_u32 s5, 0
    buffer_load_dwordx4 v16, s[40:43], s21 offen lds
    s_cbranch_scc1 L_x4_10
    s_add_u32 m0, s23, 9216
    s_nop 0
    buffer_load_dwordx4 v19, s[40:43], s21 offen lds
L_x4_10:
    s_add_u32 m0, s23, 3072
    s_nop 0
    buffer_load_dwordx4 v17, s[40:43], s21 offen lds
    s_add_u32 m0, s23, 6144
    s_nop 0
    buffer_load_dwordx4 v18, s[40:43], s21 offen lds
    s_waitcnt vmcnt(14)
    s_barrier
    s_waitcnt vmcnt(6)
    s_barrier
    s_waitcnt vmcnt(0)
    s_barrier
    s_sub_u32 s6, s28, 4
    s_lshl_b32 s6, s6, 11
    v_lshlrev_b32 v2, 4, v0
    s_mul_i32 s8, s37, 6144
    s_add_u32 s8, s8, s6
    s_add_u32 s8, s8, 5406720
    s_add_u32 s9, s6, 2048
    v_mov_b32 v3, 8
L_wok:
    s_sleep 2
    ds_read_b32 v4, v3
    s_waitcnt lgkmcnt(0)
    v_and_b32 v4, 0xfff, v4
    v_cmp_ne_u32 vcc, 0x104, v4
    s_nop 0
    s_cbranch_vccnz L_wok
    s_mov_b32 s10, 11
L_wi_11:
    s_mov_b32 m0, s9
    s_add_u32 s9, s9, 6144
    buffer_load_dwordx4 v2, s[48:51], s8 offen sc1 lds
    buffer_load_dwordx4 v2, s[48:51], s8 offen offset:1024 sc1 lds
    s_add_u32 s8, s8, 43008
    s_sub_u32 s10, s10, 1
    s_cmp_lg_u32 s10, 0
    s_waitcnt vmcnt(12)
    s_cbranch_scc1 L_wi_11
    v_mov_b32 v5, 0x1000
    s_mov_b64 exec, 1
    s_waitcnt vmcnt(12)
    ds_add_u32 v3, v5
    s_mov_b64 exec, -1
    s_mov_b32 s10, 4
L_wi_12:
    s_mov_b32 m0, s9
    s_add_u32 s9, s9, 6144
    buffer_load_dwordx4 v2, s[48:51], s8 offen sc1 lds
    buffer_load_dwordx4 v2, s[48:51], s8 offen offset:1024 sc1 lds
    s_add_u32 s8, s8, 43008
    s_sub_u32 s10, s10, 1
    s_cmp_lg_u32 s10, 0
    s_waitcnt vmcnt(12)
    s_cbranch_scc1 L_wi_12
    s_waitcnt vmcnt(0)
    v_mov_b32 v6, 0
L_wok2:
    s_sleep 1
    ds_read_b32 v4, v6 offset:24
    s_waitcnt lgkmcnt(0)
    v_cmp_ne_u32 vcc, 4, v4
    s_nop 0
    s_cbranch_vccnz L_wok2
    s_cmp_eq_u32 s28, 6
    s_cbranch_scc1 L_opoll
    s_lshl_b32 s6, s5, 10
    s_add_u32 s8, s8, s6
    s_add_u32 s9, s9, s6
    s_mov_b32 m0, s9
    s_add_u32 s9, s9, 6144
    buffer_load_dwordx4 v2, s[48:51], s8 offen sc1 lds
    buffer_load_dwordx4 v2, s[48:51], s8 offen offset:1024 sc1 lds
    buffer_load_dwordx4 v2, s[48:51], s8 offen offset:2048 sc1 lds
    s_add_u32 s8, s8, 43008
    s_mov_b32 m0, s9
    s_add_u32 s9, s9, 6144
    buffer_load_dwordx4 v2, s[48:51], s8 offen sc1 lds
    buffer_load_dwordx4 v2, s[48:51], s8 offen offset:1024 sc1 lds
    buffer_load_dwordx4 v2, s[48:51], s8 offen offset:2048 sc1 lds
    s_add_u32 s8, s8, 43008
    s_mov_b32 m0, s9
    s_add_u32 s9, s9, 6144
    buffer_load_dwordx4 v2, s[48:51], s8 offen sc1 lds
    buffer_load_dwordx4 v2, s[48:51], s8 offen offset:1024 sc1 lds
    buffer_load_dwordx4 v2, s[48:51], s8 offen offset:2048 sc1 lds
    s_add_u32 s8, s8, 43008
    s_cmp_eq_u32 s37, 6
    s_cbranch_scc1 L_wo6
    s_mov_b32 m0, s9
    s_add_u32 s9, s9, 6144
    buffer_load_dwordx4 v2, s[48:51], s8 offen sc1 lds
    buffer_load_dwordx4 v2, s[48:51], s8 offen offset:1024 sc1 lds
    buffer_load_dwordx4 v2, s[48:51], s8 offen offset:2048 sc1 lds
    s_add_u32 s8, s8, 43008
    s_mov_b32 m0, s9
    s_add_u32 s9, s9, 6144
    buffer_load_dwordx4 v2, s[48:51], s8 offen sc1 lds
    buffer_load_dwordx4 v2, s[48:51], s8 offen offset:1024 sc1 lds
    buffer_load_dwordx4 v2, s[48:51], s8 offen offset:2048 sc1 lds
    s_add_u32 s8, s8, 43008
L_wo6:
    s_waitcnt vmcnt(0)
    s_barrier
    s_endpgm
L_opoll:
    s_and_b32 s10, s36, 15
    s_lshl_b32 s10, s10, 6
    s_max_u32 s6, s10, 7
    s_sub_u32 s6, s6, 7
    s_mul_i32 s6, s6, 898
    s_lshr_b32 s6, s6, 16
    s_add_u32 s7, s10, 56
    s_mul_i32 s7, s7, 898
    s_lshr_b32 s7, s7, 16
    s_sub_u32 s7, s7, s6
    s_mul_i32 s10, s7, 0xff00
    s_or_b32 s10, s10, 0xff
    s_mov_b32 s11, 0
    s_mul_i32 s6, s36, 7
    s_add_u32 s6, s6, s37
    s_mul_i32 s6, s6, 512
    s_add_u32 s6, s6, 6422528
    v_lshl_add_u32 v3, v0, 2, s6
    v_mov_b32 v9, 0
    v_mov_b32 v2, 0
    v_mov_b32 v8, 1
    s_mov_b64 exec, s[10:11]
    global_atomic_or v4, v3, v9, s[48:49] sc0 sc1
    s_sleep 1
    global_atomic_or v5, v3, v9, s[48:49] sc0 sc1
    s_sleep 1
    global_atomic_or v6, v3, v9, s[48:49] sc0 sc1
    s_sleep 1
L_opl:
    global_atomic_or v7, v3, v9, s[48:49] sc0 sc1
    s_waitcnt vmcnt(3)
    v_cmp_ne_u32 vcc, s35, v4
    s_nop 0
    s_cbranch_vccz L_opx
    s_sleep 1
    global_atomic_or v4, v3, v9, s[48:49] sc0 sc1
    s_waitcnt vmcnt(3)
    v_cmp_ne_u32 vcc, s35, v5
    s_nop 0
    s_cbranch_vccz L_opx
    s_sleep 1
    global_atomic_or v5, v3, v9, s[48:49] sc0 sc1
    s_waitcnt vmcnt(3)
    v_cmp_ne_u32 vcc, s35, v6
    s_nop 0
    s_cbranch_vccz L_opx
    s_sleep 1
    global_atomic_or v6, v3, v9, s[48:49] sc0 sc1
    s_waitcnt vmcnt(3)
    v_cmp_ne_u32 vcc, s35, v7
    s_nop 0
    s_cbranch_vccz L_opx
    s_sleep 1
    s_sub_u32 s3, s3, 1
    s_cmp_gt_i32 s3, 0
    s_cbranch_scc1 L_opl
L_opx:
    s_barrier
    s_waitcnt lgkmcnt(0)
L_ldr_end:
    s_endpgm
L_aux:
    s_setprio 3
    s_load_dwordx2 s[20:21], s[0:1], 64
    s_load_dwordx2 s[12:13], s[0:1], 32
    s_and_b32 s6, s29, 3
    s_lshl_b32 s6, s6, 5
    s_add_u32 s6, s6, s30
    s_lshl_b32 s18, s6, 3
    s_mul_i32 s6, s18, 2560
    s_mul_i32 s7, s33, 1280
    s_add_u32 s16, s6, s7
    v_lshlrev_b32 v12, 4, v0
    s_mov_b32 m0, 153600
    s_waitcnt lgkmcnt(0)
    buffer_load_dwordx4 v2, s[40:43], s16 offen offset:0 lds
    s_mov_b32 m0, 154496
    s_nop 0
    buffer_load_dwordx4 v2, s[40:43], s16 offen offset:128 lds
    s_mov_b32 m0, 155392
    s_nop 0
    buffer_load_dwordx4 v2, s[40:43], s16 offen offset:256 lds
    s_mov_b32 m0, 156288
    s_nop 0
    buffer_load_dwordx4 v2, s[40:43], s16 offen offset:384 lds
    s_mov_b32 m0, 157184
    s_nop 0
    buffer_load_dwordx4 v2, s[40:43], s16 offen offset:512 lds
    s_mov_b32 m0, 158080
    s_nop 0
    buffer_load_dwordx4 v2, s[40:43], s16 offen offset:640 lds
    s_mov_b32 m0, 158976
    s_nop 0
    buffer_load_dwordx4 v2, s[40:43], s16 offen offset:768 lds
    s_mov_b32 m0, 159872
    s_nop 0
    buffer_load_dwordx4 v2, s[40:43], s16 offen offset:896 lds
    s_mov_b32 m0, 160768
    s_nop 0
    buffer_load_dwordx4 v2, s[40:43], s16 offen offset:1024 lds
    s_mov_b32 m0, 161664
    s_nop 0
    buffer_load_dwordx4 v2, s[40:43], s16 offen offset:1152 lds
    s_mov_b32 m0, 143360
    s_load_dword s39, s[48:49], 0
    global_load_lds_dwordx4 v12, s[20:21]
    s_mov_b64 exec, 0xffff
    global_load_lds_dwordx4 v12, s[20:21] offset:1024
    s_mov_b32 m0, 144640
    s_nop 0
    global_load_lds_dwordx4 v12, s[12:13] offset:1024
    s_mov_b64 exec, -1
    global_load_lds_dwordx4 v12, s[12:13]
    s_barrier
L_nb0:
    s_mov_b32 s3, 100000
    s_mov_b32 s50, 6946816
    s_mov_b32 s51, 0x20000
    s_mul_i32 s8, s30, 37
    s_lshr_b32 s8, s8, 8
    s_mul_i32 s9, s8, 7
    s_sub_u32 s37, s30, s9
    s_lshl_b32 s36, s29, 2
    s_add_u32 s36, s36, s8
    s_mul_i32 s4, s37, 96
    s_waitcnt lgkmcnt(0)
    s_mul_i32 s35, s39, 1664525
    s_add_u32 s35, s35, 1013904223
    v_and_b32 v8, 15, v0
    v_lshrrev_b32 v12, 4, v0
    v_cmp_eq_u32 vcc, 1, v8
    v_mov_b32 v13, 143360
    v_mov_b32 v14, 144640
    v_cndmask_b32 v13, v13, v14, vcc
    v_lshl_add_u32 v13, v12, 4, v13
    v_and_b32 v8, 7, v0
    v_lshrrev_b32 v14, 1, v8
    v_xor_b32 v14, v14, v12
    v_lshlrev_b32 v14, 4, v14
    v_lshl_add_u32 v14, v8, 7, v14
    v_add_u32 v14, 153600, v14
    v_xor_b32 v15, 64, v14
    s_waitcnt vmcnt(0)
    ds_read_b128 v[16:19], v13 offset:0
    ds_read_b128 v[20:23], v14 offset:0
    ds_read_b128 v[24:27], v13 offset:64
    ds_read_b128 v[28:31], v15 offset:0
    ds_read_b128 v[32:35], v13 offset:128
    ds_read_b128 v[36:39], v14 offset:1024
    ds_read_b128 v[40:43], v13 offset:192
    ds_read_b128 v[44:47], v15 offset:1024
    ds_read_b128 v[48:51], v13 offset:256
    ds_read_b128 v[52:55], v14 offset:2048
    ds_read_b128 v[56:59], v13 offset:320
    ds_read_b128 v[60:63], v15 offset:2048
    s_waitcnt lgkmcnt(10)
    v_mfma_f32_16x16x32_bf16 v[208:211], v[16:19], v[20:23], 0
    ds_read_b128 v[64:67], v13 offset:384
    ds_read_b128 v[68:71], v14 offset:3072
    s_waitcnt lgkmcnt(10)
    v_mfma_f32_16x16x32_bf16 v[208:211], v[24:27], v[28:31], v[208:211]
    ds_read_b128 v[72:75], v13 offset:448
    ds_read_b128 v[76:79], v15 offset:3072
    s_waitcnt lgkmcnt(10)
    v_mfma_f32_16x16x32_bf16 v[208:211], v[32:35], v[36:39], v[208:211]
    ds_read_b128 v[80:83], v13 offset:512
    ds_read_b128 v[84:87], v14 offset:4096
    s_waitcnt lgkmcnt(10)
    v_mfma_f32_16x16x32_bf16 v[208:211], v[40:43], v[44:47], v[208:211]
    ds_read_b128 v[88:91], v13 offset:576
    ds_read_b128 v[92:95], v15 offset:4096
    s_waitcnt lgkmcnt(10)
    v_mfma_f32_16x16x32_bf16 v[208:211], v[48:51], v[52:55], v[208:211]
    ds_read_b128 v[96:99], v13 offset:640
    ds_read_b128 v[100:103], v14 offset:5120
    s_waitcnt lgkmcnt(10)
    v_mfma_f32_16x16x32_bf16 v[208:211], v[56:59], v[60:63], v[208:211]
    ds_read_b128 v[104:107], v13 offset:704
    ds_read_b128 v[108:111], v15 offset:5120
    s_waitcnt lgkmcnt(10)
    v_mfma_f32_16x16x32_bf16 v[208:211], v[64:67], v[68:71], v[208:211]
    ds_read_b128 v[112:115], v13 offset:768
    ds_read_b128 v[116:119], v14 offset:6144
    s_waitcnt lgkmcnt(10)
    v_mfma_f32_16x16x32_bf16 v[208:211], v[72:75], v[76:79], v[208:211]
    ds_read_b128 v[120:123], v13 offset:832
    ds_read_b128 v[124:127], v15 offset:6144
    s_waitcnt lgkmcnt(10)
    v_mfma_f32_16x16x32_bf16 v[208:211], v[80:83], v[84:87], v[208:211]
    ds_read_b128 v[128:131], v13 offset:896
    ds_read_b128 v[132:135], v14 offset:7168
    s_waitcnt lgkmcnt(10)
    v_mfma_f32_16x16x32_bf16 v[208:211], v[88:91], v[92:95], v[208:211]
    ds_read_b128 v[136:139], v13 offset:960
    ds_read_b128 v[140:143], v15 offset:7168
    s_waitcnt lgkmcnt(10)
    v_mfma_f32_16x16x32_bf16 v[208:211], v[96:99], v[100:103], v[208:211]
    ds_read_b128 v[144:147], v13 offset:1024
    ds_read_b128 v[148:151], v14 offset:8192
    s_waitcnt lgkmcnt(10)
    v_mfma_f32_16x16x32_bf16 v[208:211], v[104:107], v[108:111], v[208:211]
    ds_read_b128 v[152:155], v13 offset:1088
    ds_read_b128 v[156:159], v15 offset:8192
    s_waitcnt lgkmcnt(10)
    v_mfma_f32_16x16x32_bf16 v[208:211], v[112:115], v[116:119], v[208:211]
    ds_read_b128 v[160:163], v13 offset:1152
    ds_read_b128 v[164:167], v14 offset:9216
    s_waitcnt lgkmcnt(10)
    v_mfma_f32_16x16x32_bf16 v[208:211], v[120:123], v[124:127], v[208:211]
    ds_read_b128 v[168:171], v13 offset:1216
    ds_read_b128 v[172:175], v15 offset:9216
    s_waitcnt lgkmcnt(10)
    v_mfma_f32_16x16x32_bf16 v[208:211], v[128:131], v[132:135], v[208:211]
    s_waitcnt lgkmcnt(8)
    v_mfma_f32_16x16x32_bf16 v[208:211], v[136:139], v[140:143], v[208:211]
    s_waitcnt lgkmcnt(6)
    v_mfma_f32_16x16x32_bf16 v[208:211], v[144:147], v[148:151], v[208:211]
    s_waitcnt lgkmcnt(4)
    v_mfma_f32_16x16x32_bf16 v[208:211], v[152:155], v[156:159], v[208:211]
    s_waitcnt lgkmcnt(2)
    v_mfma_f32_16x16x32_bf16 v[208:211], v[160:163], v[164:167], v[208:211]
    s_waitcnt lgkmcnt(0)
    v_mfma_f32_16x16x32_bf16 v[208:211], v[168:171], v[172:175], v[208:211]
    v_add_u32 v4, s18, v8
    s_mul_i32 s7, s33, 8448
    s_add_u32 s7, s7, 16384
    v_lshl_add_u32 v5, v4, 3, s7
    s_sub_u32 s7, 2047, s33
    v_lshlrev_b32 v6, 1, v4
    v_sub_u32 v6, s7, v6
    s_mul_i32 s8, s30, 512
    s_lshl_b32 s9, s29, 3
    s_add_u32 s8, s8, s9
    s_add_u32 s8, s8, 6553600
    v_mov_b32 v7, s8
    s_mov_b32 s9, 0xfffff800
    v_mov_b32 v11, s35
    v_mov_b32 v13, s35
    v_ashrrev_i32 v12, 31, v209
    v_or_b32 v12, 0x80000000, v12
    v_xor_b32 v12, v12, v209
    v_and_or_b32 v12, v12, s9, v6
    v_mul_f32 v10, 0xbfb8aa3b, v208
    v_exp_f32 v10, v10
    s_nop 0
    v_add_f32 v10, 1.0, v10
    v_rcp_f32 v10, v10
    v_max_u32_dpp v12, v12, v12 row_ror:4 row_mask:0xf bank_mask:0xf
    s_nop 1
    v_max_u32_dpp v12, v12, v12 row_ror:2 row_mask:0xf bank_mask:0xf
    s_nop 1
    v_max_u32_dpp v12, v12, v12 row_ror:1 row_mask:0xf bank_mask:0xf
    s_mov_b64 exec, 1
    buffer_atomic_swap_x2 v[12:13], v7, s[48:51], 0 offen sc1
    s_mov_b64 exec, 0xff
    buffer_store_dwordx2 v[10:11], v5, s[48:51], 0 offen sc1
    s_mov_b64 exec, -1
    s_cmp_lt_u32 s2, 224
    s_cbranch_scc1 L_aux_main
    s_cmp_lt_u32 s2, 251
    s_cbranch_scc1 L_aux_ffn
    s_cmp_eq_u32 s2, 252
    s_cbranch_scc1 L_select
    s_lshr_b32 s6, s29, 1
    s_and_b32 s6, s6, 1
    s_mul_i32 s6, s6, 7
    v_lshrrev_b32 v20, 4, v0
    v_add_u32 v20, s6, v20
    v_mul_u32_u24 v20, 73, v20
    s_lshl_b32 s7, s33, 3
    s_add_u32 s7, s7, s32
    s_lshl_b32 s7, s7, 2
    v_bfe_u32 v21, v0, 2, 2
    v_add_u32 v21, s7, v21
    v_and_b32 v22, 1, v0
    v_lshl_add_u32 v23, v21, 1, v22
    v_mul_u32_u24 v23, 16640, v23
    v_lshl_add_u32 v23, v20, 4, v23
    v_add_u32 v23, 263168, v23
    v_mul_u32_u24 v22, 57, v22
    v_add_u32 v22, v22, v20
    v_mul_u32_u24 v21, 8320, v21
    v_lshl_add_u32 v22, v22, 3, v21
    v_add_u32 v22, 2392120, v22
    v_and_b32 v21, 2, v0
    v_cmp_eq_u32 vcc, 0, v21
    s_nop 1
    v_cndmask_b32 v22, v22, v23, vcc
    v_mov_b32 v20, 2336
    v_mov_b32 v21, 4672
    v_cndmask_b32 v20, v20, v21, vcc
    v_add_u32 v23, v22, v20
    buffer_load_dword v24, v22, s[48:51], 0 offen sc1
    s_mov_b32 exec_hi, 0xffff
    buffer_load_dword v25, v23, s[48:51], 0 offen sc1
    s_mov_b64 exec, -1
    s_endpgm
L_select:
    v_lshrrev_b32 v2, 3, v0
    v_lshlrev_b32 v2, 9, v2
    v_and_b32 v3, 7, v0
    v_lshl_add_u32 v2, v3, 3, v2
    v_add_u32 v12, 6553600, v2
    v_add_u32 v13, 6557696, v2
    v_add_u32 v14, 6561792, v2
    v_add_u32 v15, 6565888, v2
    v_mov_b32 v2, 0
    v_mov_b32 v3, 0
L_sg_13:
    global_atomic_or_x2 v[4:5], v12, v[2:3], s[48:49] sc0 sc1
    global_atomic_or_x2 v[6:7], v13, v[2:3], s[48:49] sc0 sc1
    global_atomic_or_x2 v[8:9], v14, v[2:3], s[48:49] sc0 sc1
    global_atomic_or_x2 v[10:11], v15, v[2:3], s[48:49] sc0 sc1
    s_waitcnt vmcnt(0)
    v_xor_b32 v5, s35, v5
    v_xor_b32 v7, s35, v7
    v_xor_b32 v9, s35, v9
    v_or3_b32 v5, v5, v7, v9
    v_xor_b32 v11, s35, v11
    v_or_b32 v5, v5, v11
    v_cmp_ne_u32 vcc, 0, v5
    s_nop 0
    s_cbranch_vccz L_sg_13_x
    s_sub_u32 s3, s3, 1
    s_cmp_gt_i32 s3, 0
    s_cbranch_scc1 L_sg_13
L_sg_13_x:
    v_max3_u32 v4, v4, v6, v8
    v_max_u32 v4, v4, v10
    s_nop 1
    v_max_u32_dpp v4, v4, v4 row_ror:8 row_mask:0xf bank_mask:0xf
    s_nop 1
    v_max_u32_dpp v4, v4, v4 row_ror:4 row_mask:0xf bank_mask:0xf
    s_nop 1
    v_max_u32_dpp v4, v4, v4 row_ror:2 row_mask:0xf bank_mask:0xf
    s_nop 1
    v_max_u32_dpp v4, v4, v4 row_ror:1 row_mask:0xf bank_mask:0xf
    s_nop 0
    v_readlane_b32 s6, v4, 0
    v_readlane_b32 s7, v4, 16
    v_readlane_b32 s8, v4, 32
    v_readlane_b32 s9, v4, 48
    s_max_u32 s6, s6, s7
    s_max_u32 s8, s8, s9
    s_max_u32 s14, s6, s8
    s_and_b32 s15, s14, 0x7ff
    s_sub_u32 s15, 2047, s15
    v_mov_b32 v4, s14
    v_mov_b32 v5, s35
    v_lshlrev_b32 v2, 9, v0
    s_mov_b32 s6, 6930432
    s_mov_b64 exec, 134217727
    buffer_atomic_swap_x2 v[4:5], v2, s[48:51], s6 offen sc1
    s_mov_b64 exec, -1
    v_lshrrev_b32 v6, 4, v0
    v_mul_u32_u24 v6, 448, v6
    v_lshl_add_u32 v6, v0, 2, v6
    v_add_u32 v6, 6684672, v6
    v_add_u32 v7, 4096, v6
    v_mov_b32 v3, 0
    v_mov_b32 v10, s35
L_wf_14:
    global_atomic_or v8, v6, v3, s[48:49] sc0 sc1
    global_atomic_or v9, v6, v3, s[48:49] offset:2048 sc0 sc1
    s_mov_b64 exec, 0xfff
    global_atomic_or v10, v7, v3, s[48:49] sc0 sc1
    s_mov_b64 exec, -1
    s_waitcnt vmcnt(0)
    v_xor_b32 v8, s35, v8
    v_xor_b32 v9, s35, v9
    v_xor_b32 v11, s35, v10
    v_or3_b32 v8, v8, v9, v11
    v_cmp_ne_u32 vcc, 0, v8
    s_nop 0
    s_cbranch_vccz L_wf_14_x
    s_sub_u32 s3, s3, 1
    s_cmp_gt_i32 s3, 0
    s_cbranch_scc1 L_wf_14
L_wf_14_x:
    s_mov_b32 s6, 6815744
    s_bfm_b64 exec, 32, 0
    buffer_atomic_swap_x2 v[4:5], v2, s[48:51], s6 offen sc1
    s_mov_b64 exec, -1
    s_lshr_b32 s6, s29, 1
    s_and_b32 s6, s6, 1
    s_mul_i32 s6, s6, 7
    v_lshrrev_b32 v20, 4, v0
    v_add_u32 v20, s6, v20
    v_mul_u32_u24 v20, 73, v20
    s_lshl_b32 s7, s33, 3
    s_add_u32 s7, s7, s32
    s_lshl_b32 s7, s7, 2
    v_bfe_u32 v21, v0, 2, 2
    v_add_u32 v21, s7, v21
    v_and_b32 v22, 1, v0
    v_lshl_add_u32 v23, v21, 1, v22
    v_mul_u32_u24 v23, 16640, v23
    v_lshl_add_u32 v23, v20, 4, v23
    v_add_u32 v23, 263168, v23
    v_mul_u32_u24 v22, 57, v22
    v_add_u32 v22, v22, v20
    v_mul_u32_u24 v21, 8320, v21
    v_lshl_add_u32 v22, v22, 3, v21
    v_add_u32 v22, 2392120, v22
    v_and_b32 v21, 2, v0
    v_cmp_eq_u32 vcc, 0, v21
    s_nop 1
    v_cndmask_b32 v22, v22, v23, vcc
    v_mov_b32 v20, 2336
    v_mov_b32 v21, 4672
    v_cndmask_b32 v20, v20, v21, vcc
    v_add_u32 v23, v22, v20
    buffer_load_dword v24, v22, s[48:51], 0 offen sc1
    s_mov_b32 exec_hi, 0xffff
    buffer_load_dword v25, v23, s[48:51], 0 offen sc1
    s_mov_b64 exec, -1
    v_and_b32 v2, 31, v0
    v_min_u32 v2, 27, v2
    v_mul_u32_u24 v2, 512, v2
    v_lshrrev_b32 v6, 5, v0
    v_mul_u32_u24 v6, 14336, v6
    v_add_u32 v2, v2, v6
    v_add_u32 v6, 6377472, v2
    s_mov_b32 s6, 6291456
    s_mov_b32 s7, 6320128
    s_mov_b32 s8, 6348800
L_eb_15:
    buffer_load_dword v8, v2, s[48:51], s6 offen sc1
    buffer_load_dword v9, v2, s[48:51], s7 offen sc1
    buffer_load_dword v10, v2, s[48:51], s8 offen sc1
    buffer_load_dword v11, v6, s[48:51], 0 offen sc1
    s_waitcnt vmcnt(0)
    v_xor_b32 v8, s35, v8
    v_xor_b32 v9, s35, v9
    v_xor_b32 v10, s35, v10
    v_or3_b32 v8, v8, v9, v10
    v_xor_b32 v11, s35, v11
    v_or_b32 v8, v8, v11
    v_cmp_ne_u32 vcc, 0, v8
    s_nop 0
    s_cbranch_vccz L_eb_15_x
    s_sub_u32 s3, s3, 1
    s_cmp_gt_i32 s3, 0
    s_cbranch_scc1 L_eb_15
L_eb_15_x:
    v_mov_b32 v3, 0
    s_mov_b64 exec, 1
    buffer_store_dword v5, v3, s[48:51], 0 offen sc1
    s_endpgm
L_aux_ffn:
    s_setprio 3
    s_lshr_b32 s6, s2, 0
    s_mul_i32 s6, s6, 512
    s_add_u32 s6, s6, 6815744
    v_mov_b32 v6, s6
    v_mov_b32 v2, 0
    v_mov_b32 v3, 0
    s_mov_b64 exec, 1
    global_atomic_or_x2 v[4:5], v6, v[2:3], s[48:49] sc0 sc1
L_sb_16:
    s_waitcnt vmcnt(0)
    v_cmp_ne_u32 vcc, s35, v5
    s_nop 0
    s_cbranch_vccz L_sb_16_x
    s_sleep 0
    global_atomic_or_x2 v[4:5], v6, v[2:3], s[48:49] sc0 sc1
    s_sub_u32 s3, s3, 1
    s_cmp_gt_i32 s3, 0
    s_cbranch_scc1 L_sb_16
L_sb_16_x:
    v_readfirstlane_b32 s15, v4
    s_nop 0
    s_and_b32 s15, s15, 0x7ff
    s_sub_u32 s15, 2047, s15
    v_mov_b32 v3, 2048
    ds_write_b64 v3, v[4:5]
    s_mov_b64 exec, -1
    s_mul_i32 s6, s15, 1280
    v_lshlrev_b32 v2, 4, v0
    s_mov_b32 m0, 0
    s_nop 0
    buffer_load_dwordx4 v2, s[40:43], s6 offen lds
    s_mov_b64 exec, 0xffff
    buffer_load_dwordx4 v2, s[40:43], s6 offen offset:1024 lds
    s_mov_b64 exec, -1
    s_waitcnt vmcnt(0) lgkmcnt(0)
    s_lshr_b32 s6, s29, 1
    s_and_b32 s6, s6, 1
    s_mul_i32 s6, s6, 7
    v_lshrrev_b32 v20, 4, v0
    v_add_u32 v20, s6, v20
    v_mul_u32_u24 v20, 73, v20
    s_lshl_b32 s7, s33, 3
    s_add_u32 s7, s7, s32
    s_lshl_b32 s7, s7, 2
    v_bfe_u32 v21, v0, 2, 2
    v_add_u32 v21, s7, v21
    v_and_b32 v22, 1, v0
    v_lshl_add_u32 v23, v21, 1, v22
    v_mul_u32_u24 v23, 16640, v23
    v_lshl_add_u32 v23, v20, 4, v23
    v_add_u32 v23, 263168, v23
    v_mul_u32_u24 v22, 57, v22
    v_add_u32 v22, v22, v20
    v_mul_u32_u24 v21, 8320, v21
    v_lshl_add_u32 v22, v22, 3, v21
    v_add_u32 v22, 2392120, v22
    v_and_b32 v21, 2, v0
    v_cmp_eq_u32 vcc, 0, v21
    s_nop 1
    v_cndmask_b32 v22, v22, v23, vcc
    v_mov_b32 v20, 2336
    v_mov_b32 v21, 4672
    v_cndmask_b32 v20, v20, v21, vcc
    v_add_u32 v23, v22, v20
    buffer_load_dword v24, v22, s[48:51], 0 offen sc1
    s_mov_b32 exec_hi, 0xffff
    buffer_load_dword v25, v23, s[48:51], 0 offen sc1
    s_mov_b64 exec, -1
    s_barrier
    s_endpgm
L_aux_main:
    s_setprio 0
    s_mul_i32 s6, s32, 14336
    s_add_u32 s6, s6, 6291456
    s_mul_i32 s7, s31, 512
    s_add_u32 s7, s7, s6
    v_mov_b32 v6, s7
    v_min_u32 v3, 27, v0
    v_lshl_add_u32 v3, v3, 9, s6
    s_barrier
    s_barrier
    s_mov_b64 exec, 1
    buffer_store_dword v11, v6, s[48:51], 0 offen sc1
    s_mov_b64 exec, -1
    s_barrier
    s_barrier
    s_barrier
    buffer_load_dword v4, v3, s[48:51], 0 offen sc1
    s_barrier
L_pp_17:
    s_waitcnt vmcnt(0)
    v_cmp_ne_u32 vcc, s35, v4
    s_nop 0
    s_cmp_eq_u32 vcc_lo, 0
    s_cbranch_scc1 L_pp_17_x
    buffer_load_dword v4, v3, s[48:51], 0 offen sc1
    s_sub_u32 s3, s3, 1
    s_cmp_gt_i32 s3, 0
    s_cbranch_scc1 L_pp_17
L_pp_17_x:
    s_barrier
    s_barrier
    v_mov_b32 v2, 0
    v_mov_b32 v5, 0
    ds_write_b32 v2, v5
    ds_write_b32 v2, v5 offset:4
    ds_write_b32 v2, v5 offset:8
    ds_write_b32 v2, v5 offset:12
    ds_write_b32 v2, v5 offset:20
    ds_write_b32 v2, v5 offset:512
    ds_write_b32 v2, v5 offset:24
    s_waitcnt lgkmcnt(0)
    s_barrier
    s_mov_b64 exec, 0
    s_branch L_touch1
L_touched:
    s_mov_b64 exec, -1
L_bq:
    s_sleep 2
    ds_read_b32 v4, v2 offset:20
    s_waitcnt lgkmcnt(0)
    v_cmp_eq_u32 vcc, 0, v4
    s_nop 0
    s_cbranch_vccnz L_bq
    s_lshr_b32 s6, s2, 3
    s_mul_i32 s6, s6, 512
    s_add_u32 s6, s6, 6815744
    v_mov_b32 v6, s6
    v_mov_b32 v2, 0
    v_mov_b32 v3, 0
    s_mov_b64 exec, 1
    global_atomic_or_x2 v[4:5], v6, v[2:3], s[48:49] sc0 sc1
L_sb_18:
    s_waitcnt vmcnt(0)
    v_cmp_ne_u32 vcc, s35, v5
    s_nop 0
    s_cbranch_vccz L_sb_18_x
    s_sleep 4
    global_atomic_or_x2 v[4:5], v6, v[2:3], s[48:49] sc0 sc1
    s_sub_u32 s3, s3, 1
    s_cmp_gt_i32 s3, 0
    s_cbranch_scc1 L_sb_18
L_sb_18_x:
    v_readfirstlane_b32 s15, v4
    s_nop 0
    s_and_b32 s15, s15, 0x7ff
    s_sub_u32 s15, 2047, s15
    s_and_b32 s6, s15, 1
    s_lshl_b32 s6, s6, 4
    s_lshr_b32 s7, s15, 7
    s_add_u32 s6, s6, s7
    s_bfe_u32 s7, s15, 0x60001
    s_cmp_eq_u32 s6, s36
    s_cselect_b32 s17, s7, -1
    v_mov_b32 v2, 16
    v_mov_b32 v3, s17
    ds_write_b32 v2, v3
    v_mov_b32 v2, 8
    v_mov_b32 v3, 0x100
    ds_add_u32 v2, v3
    s_waitcnt lgkmcnt(0)
    s_endpgm
L_spare:
    s_cmp_lt_u32 s28, 5
    s_cbranch_scc1 L_nwt
    s_sub_u32 s6, s2, 224
    s_lshl_b32 s6, s6, 1
    s_add_u32 s6, s6, s28
    s_sub_u32 s6, s6, 5
    s_lshr_b32 s7, s6, 4
    s_add_u32 s7, s7, 1
    s_lshl_b32 s7, s7, 4
    s_add_u32 s6, s6, s7
    s_mul_i32 s6, s6, 7680
    v_min_u32 v3, 59, v0
    v_lshlrev_b32 v3, 7, v3
    s_sub_u32 s7, s6, 122880
    s_waitcnt lgkmcnt(0)
    buffer_load_dword v254, v3, s[44:47], s6 offen
L_nwt:
    s_load_dwordx2 s[56:57], s[0:1], 16
    s_load_dwordx2 s[60:61], s[0:1], 40
    s_load_dwordx2 s[64:65], s[0:1], 48
    s_load_dwordx2 s[68:69], s[0:1], 56
    s_mov_b32 s3, 100000
    s_mov_b32 s50, 6946816
    s_mov_b32 s51, 0x20000
    s_mov_b32 s58, 819200
    s_mov_b32 s59, 0x20000
    s_mov_b32 s62, 2211840
    s_mov_b32 s63, 0x20000
    s_mov_b32 s66, 2211840
    s_mov_b32 s67, 0x20000
    s_mov_b32 s70, 2211840
    s_mov_b32 s71, 0x20000
    s_sub_u32 s16, s2, 224
    s_min_u32 s6, s16, 27
    s_mul_i32 s17, s6, 4
    s_cmp_lt_u32 s28, 4
    s_cselect_b32 s18, 1, 0
    s_cmp_eq_u32 s16, 28
    s_cselect_b32 s6, 0, s16
    s_cmp_lt_u32 s6, 27
    s_cbranch_scc1 L_sp1
    s_max_u32 s6, s16, 28
    s_mul_i32 s17, s6, 7
    s_sub_u32 s17, s17, 84
    s_mov_b32 s18, 1
L_sp1:
    s_add_u32 s17, s17, s28
    s_cmp_lt_u32 s16, 27
    s_cselect_b32 s6, s28, 0
    s_cmp_lt_u32 s6, 5
    s_cbranch_scc1 L_sp2
    s_endpgm
L_sp2:
    v_mov_b32 v3, 0
    ds_write_b32 v3, v3 offset:3072
    s_waitcnt lgkmcnt(0)
    s_load_dword s39, s[48:49], 0
    s_barrier
    s_cmp_lt_u32 s16, 27
    s_cbranch_scc1 L_ffn
    s_cmp_eq_u32 s18, 0
    s_cbranch_scc1 L_sp4
L_sp3:
    s_mul_i32 s15, s17, 9363
    s_lshr_b32 s15, s15, 16
    s_mul_i32 s14, s15, 7
    s_sub_u32 s14, s17, s14
    v_and_b32 v3, 15, v0
    v_lshrrev_b32 v4, 4, v0
    v_mul_u32_u24 v12, 1280, v4
    v_lshlrev_b32 v5, 1, v4
    v_xor_b32 v5, v5, v3
    v_xor_b32 v6, 8, v5
    v_lshl_add_u32 v2, v5, 4, v12
    v_lshl_add_u32 v13, v6, 4, v12
    s_cmp_eq_u32 s14, 6
    s_cselect_b32 s6, 8, 12
    v_cmp_gt_u32 vcc, s6, v6
    s_nop 1
    v_cndmask_b32 v13, v9, v13, vcc
    v_cmp_gt_u32 vcc, s6, v5
    s_mul_i32 s6, s15, 40
    s_mul_i32 s7, s15, 160
    s_sub_u32 s7, s7, 2544
    s_cmp_lt_u32 s15, 16
    s_cselect_b32 s6, s6, s7
    s_cselect_b32 s8, 4, 20
    s_cselect_b32 s9, 8, 20
    s_mul_i32 s8, s8, 1280
    s_mul_i32 s9, s9, 1280
    v_cndmask_b32 v2, v9, v2, vcc
    s_mul_i32 s6, s6, 1280
    s_mul_i32 s7, s14, 192
    s_add_u32 s6, s6, s7
    s_lshl_b32 s10, s28, 13
    s_add_u32 s10, s10, 65536
    s_mov_b32 m0, s10
    s_nop 0
    buffer_load_dwordx4 v2, s[56:59], s6 offen  lds
    s_add_u32 m0, m0, 1024
    s_add_u32 s6, s6, s8
    buffer_load_dwordx4 v2, s[56:59], s6 offen  lds
    s_add_u32 m0, m0, 1024
    s_add_u32 s6, s6, s8
    buffer_load_dwordx4 v13, s[56:59], s6 offen  lds
    s_add_u32 m0, m0, 1024
    s_add_u32 s6, s6, s8
    buffer_load_dwordx4 v13, s[56:59], s6 offen  lds
    s_add_u32 m0, m0, 1024
    s_add_u32 s6, s6, s9
    buffer_load_dwordx4 v2, s[56:59], s6 offen  lds
    s_add_u32 m0, m0, 1024
    s_add_u32 s6, s6, s8
    buffer_load_dwordx4 v2, s[56:59], s6 offen  lds
    s_add_u32 m0, m0, 1024
    s_add_u32 s6, s6, s8
    buffer_load_dwordx4 v13, s[56:59], s6 offen  lds
    s_add_u32 m0, m0, 1024
    s_add_u32 s6, s6, s8
    buffer_load_dwordx4 v13, s[56:59], s6 offen  lds
    v_lshl_add_u32 v5, v4, 11, s10
    v_bfe_u32 v6, v0, 2, 2
    v_lshl_add_u32 v5, v6, 8, v5
    v_bfe_u32 v6, v0, 2, 3
    v_lshl_add_u32 v5, v6, 5, v5
    v_and_b32 v6, 3, v0
    v_lshl_add_u32 v5, v6, 3, v5
    v_lshlrev_b32 v6, 4, v0
    s_mul_i32 s6, s15, 3
    s_add_u32 s7, s6, 2
    s_lshl_b32 s8, s15, 1
    s_add_u32 s8, s8, 12
    s_add_u32 s9, s15, 40
    s_cmp_lt_u32 s15, 12
    s_cselect_b32 s20, s6, s8
    s_cselect_b32 s22, s7, s9
    s_add_u32 s21, s20, 1
    s_mul_i32 s12, s14, 6144
    s_add_u32 s12, s12, 5406720
    s_mul_i32 s6, s20, 21846
    s_lshr_b32 s6, s6, 16
    s_mul_i32 s6, s6, 36864
    s_lshl_b32 s20, s20, 11
    s_add_u32 s20, s20, s6
    s_add_u32 s20, s20, s12
    s_mul_i32 s6, s21, 21846
    s_lshr_b32 s6, s6, 16
    s_mul_i32 s6, s6, 36864
    s_lshl_b32 s21, s21, 11
    s_add_u32 s21, s21, s6
    s_add_u32 s21, s21, s12
    s_mul_i32 s6, s22, 21846
    s_lshr_b32 s6, s6, 16
    s_mul_i32 s6, s6, 36864
    s_lshl_b32 s22, s22, 11
    s_add_u32 s22, s22, s6
    s_add_u32 s22, s22, s12
    s_lshr_b32 s14, s17, 4
    s_mul_i32 s14, s14, 448
    s_lshl_b32 s15, s17, 2
    s_add_u32 s14, s14, s15
    s_add_u32 s14, s14, 6684672
    v_mov_b32 v8, s14
    v_lshl_add_u32 v4, v4, 8, s10
    v_add_u32 v7, s10, v6
    s_mov_b32 s11, 1056
    v_and_b32 v10, 3, v3
    v_mad_u32_u24 v10, v10, s11, v4
    v_lshrrev_b32 v11, 2, v3
    v_lshl_add_u32 v200, v11, 4, v10
    v_and_b32 v10, 1, v3
    v_mad_u32_u24 v10, v10, s11, v4
    v_lshrrev_b32 v11, 1, v3
    v_lshl_add_u32 v201, v11, 4, v10
    v_xor_b32 v192, 0, v5
    v_xor_b32 v193, 32, v5
    v_xor_b32 v194, 64, v5
    v_xor_b32 v195, 96, v5
    v_xor_b32 v196, 128, v5
    v_xor_b32 v197, 160, v5
    s_waitcnt lgkmcnt(0)
    s_mul_i32 s35, s39, 1664525
    s_add_u32 s35, s35, 1013904223
    v_mov_b32 v1, s35
    s_waitcnt vmcnt(0)
    ds_read_b64_tr_b16 v[208:209], v192 offset:0
    ds_read_b64_tr_b16 v[210:211], v192 offset:1024
    ds_read_b64_tr_b16 v[212:213], v193 offset:0
    ds_read_b64_tr_b16 v[214:215], v193 offset:1024
    ds_read_b64_tr_b16 v[216:217], v194 offset:0
    ds_read_b64_tr_b16 v[218:219], v194 offset:1024
    ds_read_b64_tr_b16 v[220:221], v195 offset:0
    ds_read_b64_tr_b16 v[222:223], v195 offset:1024
    ds_read_b64_tr_b16 v[224:225], v196 offset:0
    ds_read_b64_tr_b16 v[226:227], v196 offset:1024
    ds_read_b64_tr_b16 v[228:229], v197 offset:0
    ds_read_b64_tr_b16 v[230:231], v197 offset:1024
    s_waitcnt lgkmcnt(0)
    ds_write_b128 v200, v[208:211] offset:0
    ds_write_b128 v200, v[212:215] offset:64
    ds_write_b128 v200, v[216:219] offset:128
    ds_write_b128 v200, v[220:223] offset:192
    ds_write_b128 v201, v[224:227] offset:4224
    ds_write_b128 v201, v[228:231] offset:4352
    s_waitcnt lgkmcnt(0)
    ds_read_b128 v[208:211], v7 offset:0
    ds_read_b128 v[212:215], v7 offset:1056
    ds_read_b128 v[216:219], v7 offset:2112
    ds_read_b128 v[220:223], v7 offset:3168
    ds_read_b128 v[224:227], v7 offset:4224
    ds_read_b128 v[228:231], v7 offset:5280
    s_waitcnt lgkmcnt(5)
    buffer_store_dwordx4 v[208:211], v6, s[48:51], s20 offen offset:0 sc1
    s_waitcnt lgkmcnt(4)
    buffer_store_dwordx4 v[212:215], v6, s[48:51], s20 offen offset:1024 sc1
    s_waitcnt lgkmcnt(3)
    buffer_store_dwordx4 v[216:219], v6, s[48:51], s21 offen offset:0 sc1
    s_waitcnt lgkmcnt(2)
    buffer_store_dwordx4 v[220:223], v6, s[48:51], s21 offen offset:1024 sc1
    s_waitcnt lgkmcnt(1)
    buffer_store_dwordx4 v[224:227], v6, s[48:51], s22 offen offset:0 sc1
    s_waitcnt lgkmcnt(0)
    buffer_store_dwordx4 v[228:231], v6, s[48:51], s22 offen offset:1024 sc1
    s_waitcnt vmcnt(0)
    s_mov_b64 exec, 1
    buffer_atomic_swap v1, v8, s[48:51], 0 offen sc1
    s_mov_b64 exec, -1
L_sp4:
    s_cmp_eq_u32 s16, 28
    s_cselect_b32 s6, 0, s28
    s_cmp_lg_u32 s6, 6
    s_cbranch_scc1 L_sp6
    v_mul_u32_u24 v3, 6554, v0
    v_lshrrev_b32 v3, 16, v3
    v_mul_u32_u24 v3, 19200, v3
    v_lshl_add_u32 v3, v0, 7, v3
    v_cmp_gt_u32 vcc, 60, v0
    s_nop 1
    v_cndmask_b32 v3, v9, v3, vcc
    s_max_u32 s10, s16, 28
    s_sub_u32 s10, s10, 28
L_dpl:
    s_mul_i32 s6, s10, 3641
    s_lshr_b32 s6, s6, 16
    s_mul_i32 s7, s6, 18
    s_sub_u32 s7, s10, s7
    s_mul_i32 s7, s7, 122880
    s_mul_i32 s6, s6, 1280
    s_add_u32 s6, s6, s7
    s_add_u32 s6, s6, 16640
    buffer_load_dword v4, v3, s[68:71], s6 offen
    s_add_u32 s10, s10, 4
    s_cmp_lt_u32 s10, 54
    s_waitcnt vmcnt(4)
    s_cbranch_scc1 L_dpl
L_sp6:
    s_cmp_eq_u32 s16, 28
    s_cselect_b32 s6, 9, s28
    s_cmp_ge_u32 s6, 6
    s_cbranch_scc1 L_sp5
    s_load_dwordx2 s[52:53], s[0:1], 72
    s_mov_b32 s54, 2621440
    s_mov_b32 s55, 0x20000
    s_lshr_b32 s6, s2, 3
    s_mul_i32 s6, s6, 512
    s_add_u32 s6, s6, 6815744
    v_mov_b32 v6, s6
    v_mov_b32 v2, 0
    v_mov_b32 v3, 0
    s_mov_b64 exec, 1
    global_atomic_or_x2 v[4:5], v6, v[2:3], s[48:49] sc0 sc1
L_sb_19:
    s_waitcnt vmcnt(0)
    v_cmp_ne_u32 vcc, s35, v5
    s_nop 0
    s_cbranch_vccz L_sb_19_x
    s_sleep 4
    global_atomic_or_x2 v[4:5], v6, v[2:3], s[48:49] sc0 sc1
    s_sub_u32 s3, s3, 1
    s_cmp_gt_i32 s3, 0
    s_cbranch_scc1 L_sb_19
L_sb_19_x:
    v_readfirstlane_b32 s15, v4
    s_nop 0
    s_and_b32 s15, s15, 0x7ff
    s_sub_u32 s15, 2047, s15
    s_mov_b64 exec, -1
    s_max_u32 s16, s16, 28
    s_sub_u32 s16, s16, 28
    s_and_b32 s17, s15, 1
    s_lshr_b32 s18, s15, 1
    s_cmp_lt_u32 s28, 5
    s_cbranch_scc1 L_row
    s_max_u32 s6, s18, 7
    s_sub_u32 s6, s6, 7
    s_mul_i32 s6, s6, 898
    s_lshr_b32 s6, s6, 16
    s_and_b32 s7, s18, 0x3c0
    s_max_u32 s7, s7, 7
    s_sub_u32 s7, s7, 7
    s_mul_i32 s7, s7, 898
    s_lshr_b32 s7, s7, 16
    s_sub_u32 s6, s6, s7
    s_lshl_b32 s6, s6, 5
    s_lshr_b32 s7, s18, 6
    s_lshl_b32 s8, s17, 4
    s_add_u32 s7, s7, s8
    s_mul_i32 s7, s7, 7
    s_add_u32 s7, s7, s16
    s_mul_i32 s7, s7, 512
    s_add_u32 s6, s6, s7
    s_add_u32 s6, s6, 6422528
    v_lshl_add_u32 v6, v0, 2, s6
    s_mul_i32 s22, s17, 1064960
    s_lshl_b32 s6, s18, 4
    s_add_u32 s22, s22, s6
    s_add_u32 s22, s22, 262144
    s_mul_i32 s23, s17, 266240
    s_lshl_b32 s6, s18, 3
    s_add_u32 s23, s23, s6
    s_add_u32 s23, s23, 2392064
    v_mul_u32_u24 v7, 16640, v0
    v_mul_u32_u24 v8, 8320, v0
    v_lshlrev_b32 v9, 4, v0
    v_lshlrev_b32 v10, 3, v0
    s_mov_b64 exec, 0xff
L_rp:
    global_atomic_or v4, v6, v2, s[48:49] sc0 sc1
    s_waitcnt vmcnt(0)
    v_cmp_ne_u32 vcc, s35, v4
    s_nop 0
    s_cbranch_vccz L_rp_x
    s_sleep 1
    s_sub_u32 s3, s3, 1
    s_cmp_gt_i32 s3, 0
    s_cbranch_scc1 L_rp
L_rp_x:
    s_mov_b64 exec, -1
    buffer_load_dwordx4 v[12:15], v7, s[48:51], s22 offen sc1
    s_mov_b32 exec_hi, 0
    buffer_load_dwordx2 v[16:17], v8, s[48:51], s23 offen sc1
    s_waitcnt vmcnt(0)
    ds_write_b64 v10, v[16:17] offset:1024
    s_mov_b64 exec, -1
    ds_write_b128 v9, v[12:15]
    s_mov_b64 exec, 1
    ds_write_b32 v2, v6 offset:3072
    s_waitcnt lgkmcnt(0)
    s_branch L_sp5
L_row:
    s_mul_i32 s19, s16, 5
    s_add_u32 s19, s19, s28
    s_sub_u32 s6, s19, 1
    s_cmp_eq_u32 s19, 9
    s_cselect_b32 s6, 11, s6
    s_sub_u32 s7, s19, 9
    s_cmp_lt_u32 s7, 3
    s_cselect_b32 s19, s6, s19
    s_mul_i32 s20, s19, 21846
    s_lshr_b32 s20, s20, 16
    s_mul_i32 s21, s20, 3
    s_sub_u32 s21, s19, s21
    s_mul_i32 s22, s20, 6144
    s_add_u32 s22, s22, 5406720
    s_lshl_b32 s23, s21, 11
    s_add_u32 s23, s23, s22
    v_lshlrev_b32 v4, 4, v0
    buffer_load_dwordx4 v[16:19], v4, s[48:51], s23 offen sc1
    buffer_load_dwordx4 v[20:23], v4, s[48:51], s23 offen offset:1024 sc1
    s_add_u32 s23, s23, 43008
    s_waitcnt vmcnt(10)
    buffer_load_dwordx4 v[24:27], v4, s[48:51], s23 offen sc1
    buffer_load_dwordx4 v[28:31], v4, s[48:51], s23 offen offset:1024 sc1
    s_add_u32 s23, s23, 43008
    s_waitcnt vmcnt(10)
    buffer_load_dwordx4 v[32:35], v4, s[48:51], s23 offen sc1
    buffer_load_dwordx4 v[36:39], v4, s[48:51], s23 offen offset:1024 sc1
    s_add_u32 s23, s23, 43008
    s_waitcnt vmcnt(10)
    buffer_load_dwordx4 v[40:43], v4, s[48:51], s23 offen sc1
    buffer_load_dwordx4 v[44:47], v4, s[48:51], s23 offen offset:1024 sc1
    s_add_u32 s23, s23, 43008
    s_waitcnt vmcnt(10)
    buffer_load_dwordx4 v[48:51], v4, s[48:51], s23 offen sc1
    buffer_load_dwordx4 v[52:55], v4, s[48:51], s23 offen offset:1024 sc1
    s_add_u32 s23, s23, 43008
    s_waitcnt vmcnt(10)
    buffer_load_dwordx4 v[56:59], v4, s[48:51], s23 offen sc1
    buffer_load_dwordx4 v[60:63], v4, s[48:51], s23 offen offset:1024 sc1
    s_add_u32 s23, s23, 43008
    s_waitcnt vmcnt(10)
    buffer_load_dwordx4 v[64:67], v4, s[48:51], s23 offen sc1
    buffer_load_dwordx4 v[68:71], v4, s[48:51], s23 offen offset:1024 sc1
    s_add_u32 s23, s23, 43008
    s_waitcnt vmcnt(10)
    buffer_load_dwordx4 v[72:75], v4, s[48:51], s23 offen sc1
    buffer_load_dwordx4 v[76:79], v4, s[48:51], s23 offen offset:1024 sc1
    s_add_u32 s23, s23, 43008
    s_waitcnt vmcnt(10)
    buffer_load_dwordx4 v[80:83], v4, s[48:51], s23 offen sc1
    buffer_load_dwordx4 v[84:87], v4, s[48:51], s23 offen offset:1024 sc1
    s_add_u32 s23, s23, 43008
    s_waitcnt vmcnt(10)
    buffer_load_dwordx4 v[88:91], v4, s[48:51], s23 offen sc1
    buffer_load_dwordx4 v[92:95], v4, s[48:51], s23 offen offset:1024 sc1
    s_add_u32 s23, s23, 43008
    s_waitcnt vmcnt(10)
    buffer_load_dwordx4 v[96:99], v4, s[48:51], s23 offen sc1
    buffer_load_dwordx4 v[100:103], v4, s[48:51], s23 offen offset:1024 sc1
    s_add_u32 s23, s23, 43008
    s_waitcnt vmcnt(10)
    buffer_load_dwordx4 v[104:107], v4, s[48:51], s23 offen sc1
    buffer_load_dwordx4 v[108:111], v4, s[48:51], s23 offen offset:1024 sc1
    s_waitcnt vmcnt(10)
    s_mov_b32 s23, 518144
    s_cmp_eq_u32 s21, 0
    s_cselect_b32 s23, 516096, s23
    s_cmp_eq_u32 s21, 2
    s_cselect_b32 s23, 733184, s23
    s_add_u32 s23, s23, s22
    buffer_load_dwordx4 v[112:115], v4, s[48:51], s23 offen sc1
    buffer_load_dwordx4 v[116:119], v4, s[48:51], s23 offen offset:1024 sc1
    s_waitcnt vmcnt(10)
    s_mov_b32 s23, 559104
    s_cmp_eq_u32 s21, 0
    s_cselect_b32 s23, 520192, s23
    s_cmp_eq_u32 s21, 2
    s_cselect_b32 s23, 735232, s23
    s_add_u32 s23, s23, s22
    buffer_load_dwordx4 v[120:123], v4, s[48:51], s23 offen sc1
    buffer_load_dwordx4 v[124:127], v4, s[48:51], s23 offen offset:1024 sc1
    s_waitcnt vmcnt(10)
    s_mov_b32 s23, 563200
    s_cmp_eq_u32 s21, 0
    s_cselect_b32 s23, 561152, s23
    s_cmp_eq_u32 s21, 2
    s_cselect_b32 s23, 774144, s23
    s_add_u32 s23, s23, s22
    buffer_load_dwordx4 v[128:131], v4, s[48:51], s23 offen sc1
    buffer_load_dwordx4 v[132:135], v4, s[48:51], s23 offen offset:1024 sc1
    s_waitcnt vmcnt(10)
    s_mov_b32 s23, 604160
    s_cmp_eq_u32 s21, 0
    s_cselect_b32 s23, 602112, s23
    s_cmp_eq_u32 s21, 2
    s_cselect_b32 s23, 776192, s23
    s_add_u32 s23, s23, s22
    buffer_load_dwordx4 v[136:139], v4, s[48:51], s23 offen sc1
    buffer_load_dwordx4 v[140:143], v4, s[48:51], s23 offen offset:1024 sc1
    s_waitcnt vmcnt(10)
    s_mov_b32 s23, 645120
    s_cmp_eq_u32 s21, 0
    s_cselect_b32 s23, 606208, s23
    s_cmp_eq_u32 s21, 2
    s_cselect_b32 s23, 778240, s23
    s_add_u32 s23, s23, s22
    buffer_load_dwordx4 v[144:147], v4, s[48:51], s23 offen sc1
    buffer_load_dwordx4 v[148:151], v4, s[48:51], s23 offen offset:1024 sc1
    s_waitcnt vmcnt(10)
    s_mov_b32 s23, 649216
    s_cmp_eq_u32 s21, 0
    s_cselect_b32 s23, 647168, s23
    s_cmp_eq_u32 s21, 2
    s_cselect_b32 s23, 817152, s23
    s_add_u32 s23, s23, s22
    buffer_load_dwordx4 v[152:155], v4, s[48:51], s23 offen sc1
    buffer_load_dwordx4 v[156:159], v4, s[48:51], s23 offen offset:1024 sc1
    s_waitcnt vmcnt(10)
    s_mov_b32 s23, 690176
    s_cmp_eq_u32 s21, 0
    s_cselect_b32 s23, 688128, s23
    s_cmp_eq_u32 s21, 2
    s_cselect_b32 s23, 819200, s23
    s_add_u32 s23, s23, s22
    buffer_load_dwordx4 v[160:163], v4, s[48:51], s23 offen sc1
    buffer_load_dwordx4 v[164:167], v4, s[48:51], s23 offen offset:1024 sc1
    s_waitcnt vmcnt(10)
    s_mov_b32 s23, 731136
    s_cmp_eq_u32 s21, 0
    s_cselect_b32 s23, 692224, s23
    s_cmp_eq_u32 s21, 2
    s_cselect_b32 s23, 821248, s23
    s_add_u32 s23, s23, s22
    buffer_load_dwordx4 v[168:171], v4, s[48:51], s23 offen sc1
    buffer_load_dwordx4 v[172:175], v4, s[48:51], s23 offen offset:1024 sc1
    s_waitcnt vmcnt(10)
    s_mul_i32 s6, s20, 96
    s_lshl_b32 s7, s21, 1
    s_cmp_eq_u32 s21, 2
    s_cselect_b32 s7, 64, s7
    s_cselect_b32 s8, 1, 2
    s_add_u32 s6, s6, s7
    v_and_b32 v6, 15, v0
    v_lshrrev_b32 v5, 4, v0
    v_mul_u32_u24 v2, 5120, v5
    v_lshl_add_u32 v2, v6, 4, v2
    s_lshl_b32 s7, s19, 8
    v_add_u32 v2, s7, v2
    v_lshlrev_b32 v6, s8, v6
    v_add_u32 v6, s6, v6
    v_subrev_u32 v3, 5120, v2
    v_cmp_gt_u32 vcc, 48, v0
    s_nop 1
    v_cndmask_b32 v3, v3, v2, vcc
    v_lshlrev_b32 v6, 1, v6
    v_lshlrev_b32 v4, 4, v5
    s_mul_i32 s24, s15, 1280
    s_mul_i32 s6, s17, 8448
    s_lshl_b32 s7, s18, 3
    s_add_u32 s6, s6, s7
    s_add_u32 s6, s6, 16384
    v_mov_b32 v5, s6
    buffer_load_dword v1, v6, s[40:43], s24 offen
L_rg:
    buffer_load_dwordx2 v[8:9], v5, s[48:51], 0 offen sc1
    s_waitcnt vmcnt(0)
    v_cmp_ne_u32 vcc, s35, v9
    s_nop 0
    s_cbranch_vccz L_rg_x
    s_sub_u32 s3, s3, 1
    s_cmp_gt_i32 s3, 0
    s_cbranch_scc1 L_rg
L_rg_x:
    v_mov_b32 v7, v8
    v_mov_b32 v5, 0
L_rw:
    s_sleep 1
    ds_read_b32 v8, v5 offset:3072
    s_waitcnt lgkmcnt(0)
    v_cmp_eq_u32 vcc, 0, v8
    s_nop 0
    s_cbranch_vccnz L_rw
    ds_read_b128 v[176:179], v4 offset:0
    ds_read_b128 v[180:183], v4 offset:64
    ds_read_b128 v[184:187], v4 offset:128
    ds_read_b128 v[188:191], v4 offset:192
    ds_read_b128 v[192:195], v4 offset:256
    ds_read_b128 v[196:199], v4 offset:320
    ds_read_b128 v[200:203], v4 offset:384
    ds_read_b128 v[204:207], v4 offset:448
    ds_read_b128 v[208:211], v4 offset:512
    ds_read_b128 v[212:215], v4 offset:576
    s_mov_b32 s6, 65536
    s_waitcnt lgkmcnt(9)
    v_mfma_f32_16x16x32_bf16 v[8:11], v[176:179], v[16:19], 0
    v_mfma_f32_16x16x32_bf16 v[12:15], v[176:179], v[20:23], 0
    ds_read_b128 v[176:179], v4 offset:640
    s_waitcnt lgkmcnt(9)
    v_mfma_f32_16x16x32_bf16 v[8:11], v[180:183], v[24:27], v[8:11]
    v_mfma_f32_16x16x32_bf16 v[12:15], v[180:183], v[28:31], v[12:15]
    ds_read_b128 v[180:183], v4 offset:704
    s_waitcnt lgkmcnt(9)
    v_mfma_f32_16x16x32_bf16 v[8:11], v[184:187], v[32:35], v[8:11]
    v_mfma_f32_16x16x32_bf16 v[12:15], v[184:187], v[36:39], v[12:15]
    ds_read_b128 v[184:187], v4 offset:768
    s_waitcnt lgkmcnt(9)
    v_mfma_f32_16x16x32_bf16 v[8:11], v[188:191], v[40:43], v[8:11]
    v_mfma_f32_16x16x32_bf16 v[12:15], v[188:191], v[44:47], v[12:15]
    ds_read_b128 v[188:191], v4 offset:832
    s_waitcnt lgkmcnt(9)
    v_mfma_f32_16x16x32_bf16 v[8:11], v[192:195], v[48:51], v[8:11]
    v_mfma_f32_16x16x32_bf16 v[12:15], v[192:195], v[52:55], v[12:15]
    ds_read_b128 v[192:195], v4 offset:896
    buffer_load_dwordx4 v[216:219], v2, s[48:51], s6 offen sc1
    s_add_u32 s6, s6, 20480
    s_waitcnt lgkmcnt(9)
    v_mfma_f32_16x16x32_bf16 v[8:11], v[196:199], v[56:59], v[8:11]
    v_mfma_f32_16x16x32_bf16 v[12:15], v[196:199], v[60:63], v[12:15]
    ds_read_b128 v[196:199], v4 offset:960
    buffer_load_dwordx4 v[220:223], v2, s[48:51], s6 offen sc1
    s_add_u32 s6, s6, 20480
    s_waitcnt lgkmcnt(9)
    v_mfma_f32_16x16x32_bf16 v[8:11], v[200:203], v[64:67], v[8:11]
    v_mfma_f32_16x16x32_bf16 v[12:15], v[200:203], v[68:71], v[12:15]
    ds_read_b128 v[200:203], v4 offset:1024
    buffer_load_dwordx4 v[224:227], v2, s[48:51], s6 offen sc1
    s_add_u32 s6, s6, 20480
    s_waitcnt lgkmcnt(9)
    v_mfma_f32_16x16x32_bf16 v[8:11], v[204:207], v[72:75], v[8:11]
    v_mfma_f32_16x16x32_bf16 v[12:15], v[204:207], v[76:79], v[12:15]
    ds_read_b128 v[204:207], v4 offset:1088
    buffer_load_dwordx4 v[228:231], v2, s[48:51], s6 offen sc1
    s_add_u32 s6, s6, 20480
    s_waitcnt lgkmcnt(9)
    v_mfma_f32_16x16x32_bf16 v[8:11], v[208:211], v[80:83], v[8:11]
    v_mfma_f32_16x16x32_bf16 v[12:15], v[208:211], v[84:87], v[12:15]
    ds_read_b128 v[208:211], v4 offset:1152
    buffer_load_dwordx4 v[232:235], v2, s[48:51], s6 offen sc1
    s_add_u32 s6, s6, 20480
    s_waitcnt lgkmcnt(9)
    v_mfma_f32_16x16x32_bf16 v[8:11], v[212:215], v[88:91], v[8:11]
    v_mfma_f32_16x16x32_bf16 v[12:15], v[212:215], v[92:95], v[12:15]
    ds_read_b128 v[212:215], v4 offset:1216
    buffer_load_dwordx4 v[236:239], v2, s[48:51], s6 offen sc1
    s_add_u32 s6, s6, 20480
    s_waitcnt lgkmcnt(9)
    v_mfma_f32_16x16x32_bf16 v[8:11], v[176:179], v[96:99], v[8:11]
    v_mfma_f32_16x16x32_bf16 v[12:15], v[176:179], v[100:103], v[12:15]
    buffer_load_dwordx4 v[240:243], v3, s[48:51], s6 offen sc1
    s_add_u32 s6, s6, 20480
    s_waitcnt lgkmcnt(8)
    v_mfma_f32_16x16x32_bf16 v[8:11], v[180:183], v[104:107], v[8:11]
    v_mfma_f32_16x16x32_bf16 v[12:15], v[180:183], v[108:111], v[12:15]
    s_waitcnt lgkmcnt(7)
    v_mfma_f32_16x16x32_bf16 v[8:11], v[184:187], v[112:115], v[8:11]
    v_mfma_f32_16x16x32_bf16 v[12:15], v[184:187], v[116:119], v[12:15]
    s_waitcnt lgkmcnt(6)
    v_mfma_f32_16x16x32_bf16 v[8:11], v[188:191], v[120:123], v[8:11]
    v_mfma_f32_16x16x32_bf16 v[12:15], v[188:191], v[124:127], v[12:15]
    s_waitcnt lgkmcnt(5)
    v_mfma_f32_16x16x32_bf16 v[8:11], v[192:195], v[128:131], v[8:11]
    v_mfma_f32_16x16x32_bf16 v[12:15], v[192:195], v[132:135], v[12:15]
    s_waitcnt lgkmcnt(4)
    v_mfma_f32_16x16x32_bf16 v[8:11], v[196:199], v[136:139], v[8:11]
    v_mfma_f32_16x16x32_bf16 v[12:15], v[196:199], v[140:143], v[12:15]
    s_waitcnt lgkmcnt(3)
    v_mfma_f32_16x16x32_bf16 v[8:11], v[200:203], v[144:147], v[8:11]
    v_mfma_f32_16x16x32_bf16 v[12:15], v[200:203], v[148:151], v[12:15]
    s_waitcnt lgkmcnt(2)
    v_mfma_f32_16x16x32_bf16 v[8:11], v[204:207], v[152:155], v[8:11]
    v_mfma_f32_16x16x32_bf16 v[12:15], v[204:207], v[156:159], v[12:15]
    s_waitcnt lgkmcnt(1)
    v_mfma_f32_16x16x32_bf16 v[8:11], v[208:211], v[160:163], v[8:11]
    v_mfma_f32_16x16x32_bf16 v[12:15], v[208:211], v[164:167], v[12:15]
    s_waitcnt lgkmcnt(0)
    v_mfma_f32_16x16x32_bf16 v[8:11], v[212:215], v[168:171], v[8:11]
    v_mfma_f32_16x16x32_bf16 v[12:15], v[212:215], v[172:175], v[12:15]
L_ry:
    v_mov_b32 v48, 0
    v_mov_b32 v49, 0
    v_mov_b32 v50, 0
    v_mov_b32 v51, -1
    s_waitcnt vmcnt(6)
    v_max3_u32 v50, v50, v217, v219
    v_min3_u32 v51, v51, v217, v219
    v_add_f32 v48, v48, v216
    v_add_f32 v49, v49, v218
    s_waitcnt vmcnt(5)
    v_max3_u32 v50, v50, v221, v223
    v_min3_u32 v51, v51, v221, v223
    v_add_f32 v48, v48, v220
    v_add_f32 v49, v49, v222
    s_waitcnt vmcnt(4)
    v_max3_u32 v50, v50, v225, v227
    v_min3_u32 v51, v51, v225, v227
    v_add_f32 v48, v48, v224
    v_add_f32 v49, v49, v226
    s_waitcnt vmcnt(3)
    v_max3_u32 v50, v50, v229, v231
    v_min3_u32 v51, v51, v229, v231
    v_add_f32 v48, v48, v228
    v_add_f32 v49, v49, v230
    s_waitcnt vmcnt(2)
    v_max3_u32 v50, v50, v233, v235
    v_min3_u32 v51, v51, v233, v235
    v_add_f32 v48, v48, v232
    v_add_f32 v49, v49, v234
    s_waitcnt vmcnt(1)
    v_max3_u32 v50, v50, v237, v239
    v_min3_u32 v51, v51, v237, v239
    v_add_f32 v48, v48, v236
    v_add_f32 v49, v49, v238
    s_waitcnt vmcnt(0)
    v_max3_u32 v50, v50, v241, v243
    v_min3_u32 v51, v51, v241, v243
    s_mov_b32 exec_hi, 0xffff
    v_add_f32 v48, v48, v240
    v_add_f32 v49, v49, v242
    s_mov_b64 exec, -1
    v_xor_b32 v50, s35, v50
    v_xor_b32 v51, s35, v51
    v_or_b32 v50, v50, v51
    v_cmp_ne_u32 vcc, 0, v50
    s_nop 0
    s_cbranch_vccz L_ry_x
    s_mov_b32 s6, 65536
    buffer_load_dwordx4 v[216:219], v2, s[48:51], s6 offen sc1
    s_add_u32 s6, s6, 20480
    buffer_load_dwordx4 v[220:223], v2, s[48:51], s6 offen sc1
    s_add_u32 s6, s6, 20480
    buffer_load_dwordx4 v[224:227], v2, s[48:51], s6 offen sc1
    s_add_u32 s6, s6, 20480
    buffer_load_dwordx4 v[228:231], v2, s[48:51], s6 offen sc1
    s_add_u32 s6, s6, 20480
    buffer_load_dwordx4 v[232:235], v2, s[48:51], s6 offen sc1
    s_add_u32 s6, s6, 20480
    buffer_load_dwordx4 v[236:239], v2, s[48:51], s6 offen sc1
    s_add_u32 s6, s6, 20480
    buffer_load_dwordx4 v[240:243], v3, s[48:51], s6 offen sc1
    s_add_u32 s6, s6, 20480
    s_sub_u32 s3, s3, 1
    s_cmp_gt_i32 s3, 0
    s_cbranch_scc1 L_ry
L_ry_x:
    v_permlane16_swap_b32 v48, v49
    v_add_f32 v48, v48, v49
    v_mov_b32 v49, v48
    v_lshlrev_b32 v52, 16, v1
    v_and_b32 v53, 0xffff0000, v1
    v_permlane32_swap_b32 v48, v49
    v_add_f32 v48, v48, v49
    v_mov_b32 v49, v48
    v_sub_f32 v54, 1.0, v7
    v_mul_f32 v52, v54, v52
    v_permlane16_swap_b32 v48, v49
    v_mul_f32 v53, v54, v53
    v_fmac_f32 v52, v7, v8
    v_fmac_f32 v53, v7, v12
    v_fmac_f32 v52, v54, v48
    v_fmac_f32 v53, v54, v49
    v_cvt_pk_bf16_f32 v52, v52, v53
    s_mov_b64 exec, 0xffff
    ds_write_b32 v6, v52 offset:4096
    s_lshl_b32 s6, s19, 6
    v_lshl_add_u32 v6, v0, 2, s6
    s_waitcnt lgkmcnt(0)
    s_barrier
    ds_read_b32 v52, v6 offset:4096
    s_waitcnt lgkmcnt(0)
    buffer_store_dword v52, v6, s[52:55], s24 offen sc1
L_sp5:
    s_endpgm
L_ffn:
    v_mov_b32 v6, v9
    v_mov_b32 v8, v9
    s_cmp_eq_u32 s18, 0
    s_cbranch_scc1 L_f1
    s_mul_i32 s15, s17, 9363
    s_lshr_b32 s15, s15, 16
    s_mul_i32 s14, s15, 7
    s_sub_u32 s14, s17, s14
    v_and_b32 v3, 15, v0
    v_lshrrev_b32 v4, 4, v0
    v_mul_u32_u24 v12, 1280, v4
    v_lshlrev_b32 v5, 1, v4
    v_xor_b32 v5, v5, v3
    v_xor_b32 v6, 8, v5
    v_lshl_add_u32 v2, v5, 4, v12
    v_lshl_add_u32 v13, v6, 4, v12
    s_cmp_eq_u32 s14, 6
    s_cselect_b32 s6, 8, 12
    v_cmp_gt_u32 vcc, s6, v6
    s_nop 1
    v_cndmask_b32 v13, v9, v13, vcc
    v_cmp_gt_u32 vcc, s6, v5
    s_mul_i32 s6, s15, 40
    s_mul_i32 s7, s15, 160
    s_sub_u32 s7, s7, 2544
    s_cmp_lt_u32 s15, 16
    s_cselect_b32 s6, s6, s7
    s_cselect_b32 s8, 4, 20
    s_cselect_b32 s9, 8, 20
    s_mul_i32 s8, s8, 1280
    s_mul_i32 s9, s9, 1280
    v_cndmask_b32 v2, v9, v2, vcc
    s_mul_i32 s6, s6, 1280
    s_mul_i32 s7, s14, 192
    s_add_u32 s6, s6, s7
    s_lshl_b32 s10, s28, 13
    s_add_u32 s10, s10, 65536
    s_mov_b32 m0, s10
    s_nop 0
    buffer_load_dwordx4 v2, s[56:59], s6 offen  lds
    s_add_u32 m0, m0, 1024
    s_add_u32 s6, s6, s8
    buffer_load_dwordx4 v2, s[56:59], s6 offen  lds
    s_add_u32 m0, m0, 1024
    s_add_u32 s6, s6, s8
    buffer_load_dwordx4 v13, s[56:59], s6 offen  lds
    s_add_u32 m0, m0, 1024
    s_add_u32 s6, s6, s8
    buffer_load_dwordx4 v13, s[56:59], s6 offen  lds
    s_add_u32 m0, m0, 1024
    s_add_u32 s6, s6, s9
    buffer_load_dwordx4 v2, s[56:59], s6 offen  lds
    s_add_u32 m0, m0, 1024
    s_add_u32 s6, s6, s8
    buffer_load_dwordx4 v2, s[56:59], s6 offen  lds
    s_add_u32 m0, m0, 1024
    s_add_u32 s6, s6, s8
    buffer_load_dwordx4 v13, s[56:59], s6 offen  lds
    s_add_u32 m0, m0, 1024
    s_add_u32 s6, s6, s8
    buffer_load_dwordx4 v13, s[56:59], s6 offen  lds
    v_lshl_add_u32 v5, v4, 11, s10
    v_bfe_u32 v6, v0, 2, 2
    v_lshl_add_u32 v5, v6, 8, v5
    v_bfe_u32 v6, v0, 2, 3
    v_lshl_add_u32 v5, v6, 5, v5
    v_and_b32 v6, 3, v0
    v_lshl_add_u32 v5, v6, 3, v5
    v_lshlrev_b32 v6, 4, v0
    s_mul_i32 s6, s15, 3
    s_add_u32 s7, s6, 2
    s_lshl_b32 s8, s15, 1
    s_add_u32 s8, s8, 12
    s_add_u32 s9, s15, 40
    s_cmp_lt_u32 s15, 12
    s_cselect_b32 s20, s6, s8
    s_cselect_b32 s22, s7, s9
    s_add_u32 s21, s20, 1
    s_mul_i32 s12, s14, 6144
    s_add_u32 s12, s12, 5406720
    s_mul_i32 s6, s20, 21846
    s_lshr_b32 s6, s6, 16
    s_mul_i32 s6, s6, 36864
    s_lshl_b32 s20, s20, 11
    s_add_u32 s20, s20, s6
    s_add_u32 s20, s20, s12
    s_mul_i32 s6, s21, 21846
    s_lshr_b32 s6, s6, 16
    s_mul_i32 s6, s6, 36864
    s_lshl_b32 s21, s21, 11
    s_add_u32 s21, s21, s6
    s_add_u32 s21, s21, s12
    s_mul_i32 s6, s22, 21846
    s_lshr_b32 s6, s6, 16
    s_mul_i32 s6, s6, 36864
    s_lshl_b32 s22, s22, 11
    s_add_u32 s22, s22, s6
    s_add_u32 s22, s22, s12
    s_lshr_b32 s14, s17, 4
    s_mul_i32 s14, s14, 448
    s_lshl_b32 s15, s17, 2
    s_add_u32 s14, s14, s15
    s_add_u32 s14, s14, 6684672
    v_mov_b32 v8, s14
    v_lshl_add_u32 v4, v4, 8, s10
    v_add_u32 v7, s10, v6
    s_mov_b32 s11, 1056
    v_and_b32 v10, 3, v3
    v_mad_u32_u24 v10, v10, s11, v4
    v_lshrrev_b32 v11, 2, v3
    v_lshl_add_u32 v200, v11, 4, v10
    v_and_b32 v10, 1, v3
    v_mad_u32_u24 v10, v10, s11, v4
    v_lshrrev_b32 v11, 1, v3
    v_lshl_add_u32 v201, v11, 4, v10
    v_xor_b32 v192, 0, v5
    v_xor_b32 v193, 32, v5
    v_xor_b32 v194, 64, v5
    v_xor_b32 v195, 96, v5
    v_xor_b32 v196, 128, v5
    v_xor_b32 v197, 160, v5
    s_waitcnt lgkmcnt(0)
    s_mul_i32 s35, s39, 1664525
    s_add_u32 s35, s35, 1013904223
    v_mov_b32 v1, s35
L_f1:
    s_lshl_b32 s6, s28, 7
    v_lshrrev_b32 v2, 3, v0
    v_lshl_add_u32 v2, v2, 4, s6
    v_mul_u32_u24 v2, 3456, v2
    v_and_b32 v3, 7, v0
    v_lshl_add_u32 v2, v3, 4, v2
    v_lshrrev_b32 v12, 4, v0
    v_and_b32 v13, 15, v0
    v_mul_u32_u24 v3, 20480, v12
    v_lshl_add_u32 v3, v13, 4, v3
    s_lshl_b32 s6, s28, 8
    s_mul_i32 s7, s16, 81920
    s_add_u32 s7, s7, s6
    v_and_b32 v10, 1, v0
    v_lshl_add_u32 v10, v12, 1, v10
    v_lshl_add_u32 v10, v10, 5, s6
    s_lshl_b32 s6, s16, 7
    s_mov_b32 s24, 0x05040100
    s_mov_b32 s25, 0x07060302
    s_cmp_eq_u32 s18, 0
    s_cbranch_scc1 L_f2
    s_waitcnt vmcnt(0)
    ds_read_b64_tr_b16 v[208:209], v192 offset:0
    ds_read_b64_tr_b16 v[210:211], v192 offset:1024
    ds_read_b64_tr_b16 v[212:213], v193 offset:0
    ds_read_b64_tr_b16 v[214:215], v193 offset:1024
    ds_read_b64_tr_b16 v[216:217], v194 offset:0
    ds_read_b64_tr_b16 v[218:219], v194 offset:1024
    ds_read_b64_tr_b16 v[220:221], v195 offset:0
    ds_read_b64_tr_b16 v[222:223], v195 offset:1024
    ds_read_b64_tr_b16 v[224:225], v196 offset:0
    ds_read_b64_tr_b16 v[226:227], v196 offset:1024
    ds_read_b64_tr_b16 v[228:229], v197 offset:0
    ds_read_b64_tr_b16 v[230:231], v197 offset:1024
    s_waitcnt lgkmcnt(0)
    ds_write_b128 v200, v[208:211] offset:0
    ds_write_b128 v200, v[212:215] offset:64
    ds_write_b128 v200, v[216:219] offset:128
    ds_write_b128 v200, v[220:223] offset:192
    ds_write_b128 v201, v[224:227] offset:4224
    ds_write_b128 v201, v[228:231] offset:4352
    s_waitcnt lgkmcnt(0)
    ds_read_b128 v[208:211], v7 offset:0
    ds_read_b128 v[212:215], v7 offset:1056
    ds_read_b128 v[216:219], v7 offset:2112
    ds_read_b128 v[220:223], v7 offset:3168
    ds_read_b128 v[224:227], v7 offset:4224
    ds_read_b128 v[228:231], v7 offset:5280
    s_waitcnt lgkmcnt(5)
    buffer_store_dwordx4 v[208:211], v6, s[48:51], s20 offen offset:0 sc1
    s_waitcnt lgkmcnt(4)
    buffer_store_dwordx4 v[212:215], v6, s[48:51], s20 offen offset:1024 sc1
    s_waitcnt lgkmcnt(3)
    buffer_store_dwordx4 v[216:219], v6, s[48:51], s21 offen offset:0 sc1
    s_waitcnt lgkmcnt(2)
    buffer_store_dwordx4 v[220:223], v6, s[48:51], s21 offen offset:1024 sc1
    s_waitcnt lgkmcnt(1)
    buffer_store_dwordx4 v[224:227], v6, s[48:51], s22 offen offset:0 sc1
    s_waitcnt lgkmcnt(0)
    buffer_store_dwordx4 v[228:231], v6, s[48:51], s22 offen offset:1024 sc1
L_f2:
    buffer_load_dwordx4 v[16:19], v2, s[60:63], s6 offen nt
    buffer_load_dwordx4 v[48:51], v2, s[64:67], s6 offen nt
    s_add_u32 s6, s6, 3456
    s_waitcnt vmcnt(2)
    s_cmp_eq_u32 s18, 0
    s_cbranch_scc1 L_f3
    s_mov_b64 exec, 1
    buffer_atomic_swap v1, v8, s[48:51], 0 offen sc1
    s_mov_b64 exec, -1
L_f3:
    buffer_load_dwordx4 v[20:23], v2, s[60:63], s6 offen nt
    s_waitcnt vmcnt(8)
    buffer_load_dwordx4 v[52:55], v2, s[64:67], s6 offen nt
    s_add_u32 s6, s6, 3456
    s_waitcnt vmcnt(8)
    buffer_load_dwordx4 v[24:27], v2, s[60:63], s6 offen nt
    s_waitcnt vmcnt(8)
    buffer_load_dwordx4 v[56:59], v2, s[64:67], s6 offen nt
    s_add_u32 s6, s6, 3456
    s_waitcnt vmcnt(8)
    buffer_load_dwordx4 v[28:31], v2, s[60:63], s6 offen nt
    s_waitcnt vmcnt(8)
    buffer_load_dwordx4 v[60:63], v2, s[64:67], s6 offen nt
    s_add_u32 s6, s6, 3456
    s_waitcnt vmcnt(8)
    buffer_load_dwordx4 v[32:35], v2, s[60:63], s6 offen nt
    s_waitcnt vmcnt(8)
    buffer_load_dwordx4 v[64:67], v2, s[64:67], s6 offen nt
    s_add_u32 s6, s6, 3456
    s_waitcnt vmcnt(8)
    buffer_load_dwordx4 v[36:39], v2, s[60:63], s6 offen nt
    s_waitcnt vmcnt(8)
    buffer_load_dwordx4 v[68:71], v2, s[64:67], s6 offen nt
    s_add_u32 s6, s6, 3456
    s_waitcnt vmcnt(8)
    buffer_load_dwordx4 v[40:43], v2, s[60:63], s6 offen nt
    s_waitcnt vmcnt(8)
    buffer_load_dwordx4 v[72:75], v2, s[64:67], s6 offen nt
    s_add_u32 s6, s6, 3456
    s_waitcnt vmcnt(8)
    buffer_load_dwordx4 v[44:47], v2, s[60:63], s6 offen nt
    s_waitcnt vmcnt(8)
    buffer_load_dwordx4 v[76:79], v2, s[64:67], s6 offen nt
    s_add_u32 s6, s6, 3456
    s_waitcnt vmcnt(8)
    buffer_load_dwordx4 v[80:83], v2, s[60:63], s6 offen nt
    s_waitcnt vmcnt(8)
    buffer_load_dwordx4 v[112:115], v2, s[64:67], s6 offen nt
    s_add_u32 s6, s6, 3456
    s_waitcnt vmcnt(8)
    buffer_load_dwordx4 v[84:87], v2, s[60:63], s6 offen nt
    s_waitcnt vmcnt(8)
    buffer_load_dwordx4 v[116:119], v2, s[64:67], s6 offen nt
    s_add_u32 s6, s6, 3456
    s_waitcnt vmcnt(8)
    buffer_load_dwordx4 v[88:91], v2, s[60:63], s6 offen nt
    s_waitcnt vmcnt(8)
    buffer_load_dwordx4 v[120:123], v2, s[64:67], s6 offen nt
    s_add_u32 s6, s6, 3456
    s_waitcnt vmcnt(8)
    buffer_load_dwordx4 v[92:95], v2, s[60:63], s6 offen nt
    s_waitcnt vmcnt(8)
    buffer_load_dwordx4 v[124:127], v2, s[64:67], s6 offen nt
    s_add_u32 s6, s6, 3456
    s_waitcnt vmcnt(8)
    v_perm_b32 v208, v20, v16, s24
    v_perm_b32 v212, v20, v16, s25
    v_perm_b32 v216, v21, v17, s24
    v_perm_b32 v220, v21, v17, s25
    v_perm_b32 v224, v22, v18, s24
    v_perm_b32 v228, v22, v18, s25
    v_perm_b32 v232, v23, v19, s24
    v_perm_b32 v236, v23, v19, s25
    v_perm_b32 v209, v28, v24, s24
    v_perm_b32 v213, v28, v24, s25
    v_perm_b32 v217, v29, v25, s24
    v_perm_b32 v221, v29, v25, s25
    v_perm_b32 v225, v30, v26, s24
    v_perm_b32 v229, v30, v26, s25
    v_perm_b32 v233, v31, v27, s24
    v_perm_b32 v237, v31, v27, s25
    v_perm_b32 v210, v36, v32, s24
    v_perm_b32 v214, v36, v32, s25
    v_perm_b32 v218, v37, v33, s24
    v_perm_b32 v222, v37, v33, s25
    v_perm_b32 v226, v38, v34, s24
    v_perm_b32 v230, v38, v34, s25
    v_perm_b32 v234, v39, v35, s24
    v_perm_b32 v238, v39, v35, s25
    v_perm_b32 v211, v44, v40, s24
    v_perm_b32 v215, v44, v40, s25
    v_perm_b32 v219, v45, v41, s24
    v_perm_b32 v223, v45, v41, s25
    v_perm_b32 v227, v46, v42, s24
    v_perm_b32 v231, v46, v42, s25
    v_perm_b32 v235, v47, v43, s24
    v_perm_b32 v239, v47, v43, s25
    buffer_load_dwordx4 v[96:99], v2, s[60:63], s6 offen nt
    v_perm_b32 v16, v52, v48, s24
    v_perm_b32 v20, v52, v48, s25
    v_perm_b32 v24, v53, v49, s24
    v_perm_b32 v28, v53, v49, s25
    v_perm_b32 v32, v54, v50, s24
    v_perm_b32 v36, v54, v50, s25
    v_perm_b32 v40, v55, v51, s24
    v_perm_b32 v44, v55, v51, s25
    v_perm_b32 v17, v60, v56, s24
    v_perm_b32 v21, v60, v56, s25
    v_perm_b32 v25, v61, v57, s24
    v_perm_b32 v29, v61, v57, s25
    v_perm_b32 v33, v62, v58, s24
    v_perm_b32 v37, v62, v58, s25
    v_perm_b32 v41, v63, v59, s24
    v_perm_b32 v45, v63, v59, s25
    v_perm_b32 v18, v68, v64, s24
    v_perm_b32 v22, v68, v64, s25
    v_perm_b32 v26, v69, v65, s24
    v_perm_b32 v30, v69, v65, s25
    v_perm_b32 v34, v70, v66, s24
    v_perm_b32 v38, v70, v66, s25
    v_perm_b32 v42, v71, v67, s24
    v_perm_b32 v46, v71, v67, s25
    v_perm_b32 v19, v76, v72, s24
    v_perm_b32 v23, v76, v72, s25
    v_perm_b32 v27, v77, v73, s24
    v_perm_b32 v31, v77, v73, s25
    v_perm_b32 v35, v78, v74, s24
    v_perm_b32 v39, v78, v74, s25
    v_perm_b32 v43, v79, v75, s24
    v_perm_b32 v47, v79, v75, s25
    buffer_load_dwordx4 v[128:131], v2, s[64:67], s6 offen nt
    s_add_u32 s6, s6, 3456
    s_barrier
    v_mov_b32 v4, 2048
    ds_read_b128 v[240:243], v10
    ds_read_b128 v[244:247], v10 offset:16
    ds_read_b64 v[14:15], v4
    buffer_load_dwordx4 v[100:103], v2, s[60:63], s6 offen nt
    buffer_load_dwordx4 v[132:135], v2, s[64:67], s6 offen nt
    s_add_u32 s6, s6, 3456
    s_lshl_b32 s10, s28, 9
    v_lshrrev_b32 v4, 5, v0
    v_lshl_add_u32 v4, v4, 8, s10
    v_and_b32 v5, 7, v0
    v_lshl_add_u32 v4, v5, 5, v4
    v_and_b32 v5, 16, v0
    v_add_u32 v4, v4, v5
    v_lshlrev_b32 v5, 2, v0
    s_mov_b32 s10, 0x00ff00ff
    s_mov_b32 s11, s10
    s_waitcnt lgkmcnt(0)
    v_mfma_f32_16x16x32_bf16 v[48:51], v[240:243], v[208:211], 0
    v_mfma_f32_16x16x32_bf16 v[52:55], v[240:243], v[212:215], 0
    buffer_load_dwordx4 v[104:107], v2, s[60:63], s6 offen nt
    v_mfma_f32_16x16x32_bf16 v[56:59], v[240:243], v[216:219], 0
    v_mfma_f32_16x16x32_bf16 v[60:63], v[240:243], v[220:223], 0
    v_mfma_f32_16x16x32_bf16 v[64:67], v[240:243], v[224:227], 0
    v_mfma_f32_16x16x32_bf16 v[68:71], v[240:243], v[228:231], 0
    buffer_load_dwordx4 v[136:139], v2, s[64:67], s6 offen nt
    s_add_u32 s6, s6, 3456
    v_mfma_f32_16x16x32_bf16 v[72:75], v[240:243], v[232:235], 0
    v_mfma_f32_16x16x32_bf16 v[76:79], v[240:243], v[236:239], 0
    v_mfma_f32_16x16x32_bf16 v[208:211], v[240:243], v[16:19], 0
    v_mfma_f32_16x16x32_bf16 v[212:215], v[240:243], v[20:23], 0
    buffer_load_dwordx4 v[108:111], v2, s[60:63], s6 offen nt
    v_mfma_f32_16x16x32_bf16 v[216:219], v[240:243], v[24:27], 0
    v_mfma_f32_16x16x32_bf16 v[220:223], v[240:243], v[28:31], 0
    v_mfma_f32_16x16x32_bf16 v[224:227], v[240:243], v[32:35], 0
    v_mfma_f32_16x16x32_bf16 v[228:231], v[240:243], v[36:39], 0
    buffer_load_dwordx4 v[140:143], v2, s[64:67], s6 offen nt
    s_add_u32 s6, s6, 3456
    v_mfma_f32_16x16x32_bf16 v[232:235], v[240:243], v[40:43], 0
    v_mfma_f32_16x16x32_bf16 v[236:239], v[240:243], v[44:47], 0
    buffer_load_dwordx4 v[144:147], v3, s[68:71], s7 offen nt
    s_add_u32 s7, s7, 1280
    s_waitcnt vmcnt(8)
    buffer_load_dwordx4 v[148:151], v3, s[68:71], s7 offen nt
    s_add_u32 s7, s7, 1280
    s_waitcnt vmcnt(8)
    buffer_load_dwordx4 v[152:155], v3, s[68:71], s7 offen nt
    s_add_u32 s7, s7, 1280
    s_waitcnt vmcnt(8)
    buffer_load_dwordx4 v[156:159], v3, s[68:71], s7 offen nt
    s_add_u32 s7, s7, 1280
    s_waitcnt vmcnt(8)
    buffer_load_dwordx4 v[160:163], v3, s[68:71], s7 offen nt
    s_add_u32 s7, s7, 1280
    s_waitcnt vmcnt(8)
    buffer_load_dwordx4 v[164:167], v3, s[68:71], s7 offen nt
    s_add_u32 s7, s7, 1280
    s_waitcnt vmcnt(8)
    buffer_load_dwordx4 v[168:171], v3, s[68:71], s7 offen nt
    s_add_u32 s7, s7, 1280
    s_waitcnt vmcnt(8)
    buffer_load_dwordx4 v[172:175], v3, s[68:71], s7 offen nt
    s_add_u32 s7, s7, 1280
    s_waitcnt vmcnt(8)
    s_waitcnt vmcnt(8)
    v_perm_b32 v16, v84, v80, s24
    v_perm_b32 v20, v84, v80, s25
    v_perm_b32 v24, v85, v81, s24
    v_perm_b32 v28, v85, v81, s25
    v_perm_b32 v32, v86, v82, s24
    v_perm_b32 v36, v86, v82, s25
    v_perm_b32 v40, v87, v83, s24
    v_perm_b32 v44, v87, v83, s25
    v_perm_b32 v17, v92, v88, s24
    v_perm_b32 v21, v92, v88, s25
    v_perm_b32 v25, v93, v89, s24
    v_perm_b32 v29, v93, v89, s25
    v_perm_b32 v33, v94, v90, s24
    v_perm_b32 v37, v94, v90, s25
    v_perm_b32 v41, v95, v91, s24
    v_perm_b32 v45, v95, v91, s25
    v_perm_b32 v18, v100, v96, s24
    v_perm_b32 v22, v100, v96, s25
    v_perm_b32 v26, v101, v97, s24
    v_perm_b32 v30, v101, v97, s25
    v_perm_b32 v34, v102, v98, s24
    v_perm_b32 v38, v102, v98, s25
    v_perm_b32 v42, v103, v99, s24
    v_perm_b32 v46, v103, v99, s25
    v_perm_b32 v19, v108, v104, s24
    v_perm_b32 v23, v108, v104, s25
    v_perm_b32 v27, v109, v105, s24
    v_perm_b32 v31, v109, v105, s25
    v_perm_b32 v35, v110, v106, s24
    v_perm_b32 v39, v110, v106, s25
    v_perm_b32 v43, v111, v107, s24
    v_perm_b32 v47, v111, v107, s25
    buffer_load_dwordx4 v[176:179], v3, s[68:71], s7 offen nt
    s_add_u32 s7, s7, 1280
    v_mfma_f32_16x16x32_bf16 v[48:51], v[244:247], v[16:19], v[48:51]
    v_mfma_f32_16x16x32_bf16 v[52:55], v[244:247], v[20:23], v[52:55]
    buffer_load_dwordx4 v[180:183], v3, s[68:71], s7 offen nt
    s_add_u32 s7, s7, 1280
    v_mfma_f32_16x16x32_bf16 v[56:59], v[244:247], v[24:27], v[56:59]
    v_mfma_f32_16x16x32_bf16 v[60:63], v[244:247], v[28:31], v[60:63]
    v_mfma_f32_16x16x32_bf16 v[64:67], v[244:247], v[32:35], v[64:67]
    v_mfma_f32_16x16x32_bf16 v[68:71], v[244:247], v[36:39], v[68:71]
    buffer_load_dwordx4 v[184:187], v3, s[68:71], s7 offen nt
    s_add_u32 s7, s7, 1280
    v_mfma_f32_16x16x32_bf16 v[72:75], v[244:247], v[40:43], v[72:75]
    v_mfma_f32_16x16x32_bf16 v[76:79], v[244:247], v[44:47], v[76:79]
    v_perm_b32 v80, v116, v112, s24
    v_perm_b32 v84, v116, v112, s25
    v_perm_b32 v88, v117, v113, s24
    v_perm_b32 v92, v117, v113, s25
    v_perm_b32 v96, v118, v114, s24
    v_perm_b32 v100, v118, v114, s25
    v_perm_b32 v104, v119, v115, s24
    v_perm_b32 v108, v119, v115, s25
    v_perm_b32 v81, v124, v120, s24
    v_perm_b32 v85, v124, v120, s25
    v_perm_b32 v89, v125, v121, s24
    v_perm_b32 v93, v125, v121, s25
    v_perm_b32 v97, v126, v122, s24
    v_perm_b32 v101, v126, v122, s25
    v_perm_b32 v105, v127, v123, s24
    v_perm_b32 v109, v127, v123, s25
    v_perm_b32 v82, v132, v128, s24
    v_perm_b32 v86, v132, v128, s25
    v_perm_b32 v90, v133, v129, s24
    v_perm_b32 v94, v133, v129, s25
    v_perm_b32 v98, v134, v130, s24
    v_perm_b32 v102, v134, v130, s25
    v_perm_b32 v106, v135, v131, s24
    v_perm_b32 v110, v135, v131, s25
    v_perm_b32 v83, v140, v136, s24
    v_perm_b32 v87, v140, v136, s25
    v_perm_b32 v91, v141, v137, s24
    v_perm_b32 v95, v141, v137, s25
    v_perm_b32 v99, v142, v138, s24
    v_perm_b32 v103, v142, v138, s25
    v_perm_b32 v107, v143, v139, s24
    v_perm_b32 v111, v143, v139, s25
    buffer_load_dwordx4 v[188:191], v3, s[68:71], s7 offen nt
    s_add_u32 s7, s7, 1280
    v_mfma_f32_16x16x32_bf16 v[208:211], v[244:247], v[80:83], v[208:211]
    v_mfma_f32_16x16x32_bf16 v[212:215], v[244:247], v[84:87], v[212:215]
    buffer_load_dwordx4 v[192:195], v3, s[68:71], s7 offen nt
    s_add_u32 s7, s7, 1280
    v_mfma_f32_16x16x32_bf16 v[216:219], v[244:247], v[88:91], v[216:219]
    v_mfma_f32_16x16x32_bf16 v[220:223], v[244:247], v[92:95], v[220:223]
    v_mfma_f32_16x16x32_bf16 v[224:227], v[244:247], v[96:99], v[224:227]
    v_mfma_f32_16x16x32_bf16 v[228:231], v[244:247], v[100:103], v[228:231]
    buffer_load_dwordx4 v[196:199], v3, s[68:71], s7 offen nt
    s_add_u32 s7, s7, 1280
    v_mfma_f32_16x16x32_bf16 v[232:235], v[244:247], v[104:107], v[232:235]
    v_mfma_f32_16x16x32_bf16 v[236:239], v[244:247], v[108:111], v[236:239]
    v_add_f32_dpp v248, v49, v48 row_ror:8 row_mask:0x1 bank_mask:0xf
    v_add_f32_dpp v249, v53, v52 row_ror:8 row_mask:0x1 bank_mask:0xf
    v_add_f32_dpp v250, v57, v56 row_ror:8 row_mask:0x1 bank_mask:0xf
    v_add_f32_dpp v251, v61, v60 row_ror:8 row_mask:0x1 bank_mask:0xf
    v_add_f32_dpp v248, v65, v64 row_ror:8 row_mask:0x2 bank_mask:0xf
    v_add_f32_dpp v249, v69, v68 row_ror:8 row_mask:0x2 bank_mask:0xf
    v_add_f32_dpp v250, v73, v72 row_ror:8 row_mask:0x2 bank_mask:0xf
    v_add_f32_dpp v251, v77, v76 row_ror:8 row_mask:0x2 bank_mask:0xf
    v_add_f32_dpp v248, v209, v208 row_ror:8 row_mask:0x4 bank_mask:0xf
    v_add_f32_dpp v249, v213, v212 row_ror:8 row_mask:0x4 bank_mask:0xf
    v_add_f32_dpp v250, v217, v216 row_ror:8 row_mask:0x4 bank_mask:0xf
    v_add_f32_dpp v251, v221, v220 row_ror:8 row_mask:0x4 bank_mask:0xf
    v_add_f32_dpp v248, v225, v224 row_ror:8 row_mask:0x8 bank_mask:0xf
    v_add_f32_dpp v249, v229, v228 row_ror:8 row_mask:0x8 bank_mask:0xf
    v_add_f32_dpp v250, v233, v232 row_ror:8 row_mask:0x8 bank_mask:0xf
    v_add_f32_dpp v251, v237, v236 row_ror:8 row_mask:0x8 bank_mask:0xf
    s_mov_b64 exec, s[10:11]
    ds_write_b128 v4, v[248:251] offset:4096
    s_mov_b64 exec, -1
    buffer_load_dwordx4 v[200:203], v3, s[68:71], s7 offen nt
    s_add_u32 s7, s7, 1280
    buffer_load_dwordx4 v[204:207], v3, s[68:71], s7 offen nt
    s_add_u32 s7, s7, 1280
    s_waitcnt lgkmcnt(0)
    s_barrier
    ds_read_b32 v16, v5 offset:4096
    ds_read_b32 v17, v5 offset:4352
    ds_read_b32 v18, v5 offset:4608
    ds_read_b32 v19, v5 offset:4864
    ds_read_b32 v20, v5 offset:5120
    ds_read_b32 v21, v5 offset:5376
    ds_read_b32 v22, v5 offset:5632
    ds_read_b32 v23, v5 offset:5888
    ds_read_b32 v24, v5 offset:6144
    ds_read_b32 v25, v5 offset:6400
    s_lshl_b32 s10, s28, 7
    v_lshl_add_u32 v6, v0, 1, s10
    v_lshl_add_u32 v7, v12, 5, s10
    v_and_b32 v8, 0xfffff800, v14
    v_or_b32 v8, 0x400, v8
    v_not_b32 v9, v8
    v_ashrrev_i32 v9, 31, v9
    v_or_b32 v9, 0x80000000, v9
    v_xor_b32 v8, v8, v9
    v_mul_f32 v8, 0xbfb8aa3b, v8
    v_exp_f32 v8, v8
    s_nop 0
    v_add_f32 v8, 1.0, v8
    v_rcp_f32 v8, v8
    s_waitcnt lgkmcnt(0)
    v_add_f32 v16, v16, v18
    v_add_f32 v17, v17, v19
    v_add_f32 v16, v16, v20
    v_add_f32 v17, v17, v21
    v_add_f32 v16, v16, v22
    v_add_f32 v17, v17, v23
    v_add_f32 v16, v16, v24
    v_add_f32 v17, v17, v25
    v_mul_f32 v18, 0xbfb8aa3b, v16
    v_exp_f32 v18, v18
    v_mul_f32 v16, v16, v17
    v_add_f32 v18, 1.0, v18
    v_rcp_f32 v18, v18
    s_nop 0
    v_mul_f32 v16, v16, v18
    v_cvt_pk_bf16_f32 v16, v16, v16
    ds_write_b16 v6, v16 offset:8192
    s_waitcnt lgkmcnt(0)
    ds_read_b128 v[240:243], v7 offset:8192
    ds_read_b128 v[244:247], v7 offset:8208
    s_mul_i32 s6, s16, 5120
    s_add_u32 s6, s6, 65536
    s_lshl_b32 s7, s28, 6
    v_lshl_add_u32 v4, v13, 2, v12
    v_add_u32 v4, s7, v4
    v_mul_u32_u24 v5, 1366, v4
    v_lshrrev_b32 v5, 16, v5
    v_mul_u32_u24 v5, 48, v5
    v_sub_u32 v6, v4, v5
    v_and_b32 v9, 1, v6
    v_lshl_add_u32 v5, v9, 4, v5
    v_lshrrev_b32 v9, 1, v6
    v_add_u32 v5, v5, v9
    v_cmp_gt_u32 vcc, 32, v6
    s_nop 1
    v_cndmask_b32 v6, v4, v5, vcc
    v_lshlrev_b32 v6, 4, v6
    v_mov_b32 v249, v15
    v_mov_b32 v251, v15
    s_waitcnt vmcnt(8) lgkmcnt(0)
    v_perm_b32 v48, v148, v144, s24
    v_perm_b32 v52, v148, v144, s25
    v_perm_b32 v56, v149, v145, s24
    v_perm_b32 v60, v149, v145, s25
    v_perm_b32 v64, v150, v146, s24
    v_perm_b32 v68, v150, v146, s25
    v_perm_b32 v72, v151, v147, s24
    v_perm_b32 v76, v151, v147, s25
    v_perm_b32 v49, v156, v152, s24
    v_perm_b32 v53, v156, v152, s25
    v_perm_b32 v57, v157, v153, s24
    v_perm_b32 v61, v157, v153, s25
    v_perm_b32 v65, v158, v154, s24
    v_perm_b32 v69, v158, v154, s25
    v_perm_b32 v73, v159, v155, s24
    v_perm_b32 v77, v159, v155, s25
    v_perm_b32 v50, v164, v160, s24
    v_perm_b32 v54, v164, v160, s25
    v_perm_b32 v58, v165, v161, s24
    v_perm_b32 v62, v165, v161, s25
    v_perm_b32 v66, v166, v162, s24
    v_perm_b32 v70, v166, v162, s25
    v_perm_b32 v74, v167, v163, s24
    v_perm_b32 v78, v167, v163, s25
    v_perm_b32 v51, v172, v168, s24
    v_perm_b32 v55, v172, v168, s25
    v_perm_b32 v59, v173, v169, s24
    v_perm_b32 v63, v173, v169, s25
    v_perm_b32 v67, v174, v170, s24
    v_perm_b32 v71, v174, v170, s25
    v_perm_b32 v75, v175, v171, s24
    v_perm_b32 v79, v175, v171, s25
    v_mfma_f32_16x16x32_bf16 v[112:115], v[240:243], v[48:51], 0
    v_mfma_f32_16x16x32_bf16 v[116:119], v[240:243], v[52:55], 0
    v_mfma_f32_16x16x32_bf16 v[120:123], v[240:243], v[56:59], 0
    v_mfma_f32_16x16x32_bf16 v[124:127], v[240:243], v[60:63], 0
    v_mfma_f32_16x16x32_bf16 v[128:131], v[240:243], v[64:67], 0
    v_mfma_f32_16x16x32_bf16 v[132:135], v[240:243], v[68:71], 0
    v_mfma_f32_16x16x32_bf16 v[136:139], v[240:243], v[72:75], 0
    v_mfma_f32_16x16x32_bf16 v[140:143], v[240:243], v[76:79], 0
    s_waitcnt vmcnt(0)
    v_perm_b32 v80, v180, v176, s24
    v_perm_b32 v84, v180, v176, s25
    v_perm_b32 v88, v181, v177, s24
    v_perm_b32 v92, v181, v177, s25
    v_perm_b32 v96, v182, v178, s24
    v_perm_b32 v100, v182, v178, s25
    v_perm_b32 v104, v183, v179, s24
    v_perm_b32 v108, v183, v179, s25
    v_perm_b32 v81, v188, v184, s24
    v_perm_b32 v85, v188, v184, s25
    v_perm_b32 v89, v189, v185, s24
    v_perm_b32 v93, v189, v185, s25
    v_perm_b32 v97, v190, v186, s24
    v_perm_b32 v101, v190, v186, s25
    v_perm_b32 v105, v191, v187, s24
    v_perm_b32 v109, v191, v187, s25
    v_perm_b32 v82, v196, v192, s24
    v_perm_b32 v86, v196, v192, s25
    v_perm_b32 v90, v197, v193, s24
    v_perm_b32 v94, v197, v193, s25
    v_perm_b32 v98, v198, v194, s24
    v_perm_b32 v102, v198, v194, s25
    v_perm_b32 v106, v199, v195, s24
    v_perm_b32 v110, v199, v195, s25
    v_perm_b32 v83, v204, v200, s24
    v_perm_b32 v87, v204, v200, s25
    v_perm_b32 v91, v205, v201, s24
    v_perm_b32 v95, v205, v201, s25
    v_perm_b32 v99, v206, v202, s24
    v_perm_b32 v103, v206, v202, s25
    v_perm_b32 v107, v207, v203, s24
    v_perm_b32 v111, v207, v203, s25
    v_mfma_f32_16x16x32_bf16 v[112:115], v[244:247], v[80:83], v[112:115]
    v_mfma_f32_16x16x32_bf16 v[116:119], v[244:247], v[84:87], v[116:119]
    v_mfma_f32_16x16x32_bf16 v[120:123], v[244:247], v[88:91], v[120:123]
    v_mfma_f32_16x16x32_bf16 v[124:127], v[244:247], v[92:95], v[124:127]
    v_mfma_f32_16x16x32_bf16 v[128:131], v[244:247], v[96:99], v[128:131]
    v_mfma_f32_16x16x32_bf16 v[132:135], v[244:247], v[100:103], v[132:135]
    v_mfma_f32_16x16x32_bf16 v[136:139], v[244:247], v[104:107], v[136:139]
    v_mfma_f32_16x16x32_bf16 v[140:143], v[244:247], v[108:111], v[140:143]
    s_nop 0
    v_mul_f32_dpp v248, v112, v8 quad_perm:[0,1,2,3] row_mask:0x1 bank_mask:0xf
    v_mul_f32_dpp v250, v116, v8 quad_perm:[0,1,2,3] row_mask:0x1 bank_mask:0xf
    s_nop 0
    v_mul_f32_dpp v248, v120, v8 quad_perm:[0,1,2,3] row_mask:0x2 bank_mask:0xf
    v_mul_f32_dpp v250, v124, v8 quad_perm:[0,1,2,3] row_mask:0x2 bank_mask:0xf
    s_nop 0
    v_mul_f32_dpp v248, v128, v8 quad_perm:[0,1,2,3] row_mask:0x4 bank_mask:0xf
    v_mul_f32_dpp v250, v132, v8 quad_perm:[0,1,2,3] row_mask:0x4 bank_mask:0xf
    s_nop 0
    v_mul_f32_dpp v248, v136, v8 quad_perm:[0,1,2,3] row_mask:0x8 bank_mask:0xf
    v_mul_f32_dpp v250, v140, v8 quad_perm:[0,1,2,3] row_mask:0x8 bank_mask:0xf
    buffer_store_dwordx4 v[248:251], v6, s[48:51], s6 offen sc1
    s_endpgm
.p2align 6
L_compute:
    s_and_b32 s8, s29, 1
    s_sub_u32 s7, s7, s8
    s_mul_i32 s6, s6, 6
    s_add_u32 s6, s6, s7
    s_cmp_lt_u32 s7, 6
    s_cselect_b32 s6, s6, 99
    s_cmp_lt_u32 s28, 2
    s_cselect_b32 s38, s6, 99
    s_cmp_ge_u32 s38, 24
    v_mov_b32 v17, v9
    v_mov_b32 v198, v9
    v_mov_b32 v235, v9
    s_mov_b32 s12, 0
    s_cbranch_scc1 L_npk0
    v_and_b32 v3, 31, v0
    v_mul_u32_u24 v4, 26, v3
    v_lshrrev_b32 v4, 8, v4
    v_mul_u32_u24 v4, 1120, v4
    v_lshl_add_u32 v4, v3, 4, v4
    v_lshrrev_b32 v5, 5, v0
    v_mul_u32_u24 v5, 3840, v5
    v_add_u32 v4, v4, v5
    v_cmp_gt_u32 vcc, 30, v3
    s_lshl_b32 s8, s38, 1
    s_add_u32 s8, s8, s28
    s_mul_i32 s8, s8, 30720
    s_mul_i32 s10, s32, 160
    s_add_u32 s8, s8, s10
    s_add_u32 s8, s8, 983040
    v_cndmask_b32 v4, v9, v4, vcc
    s_mul_i32 s11, s28, 4224
    s_add_u32 s11, s11, 133120
    s_mov_b32 m0, s11
    s_waitcnt lgkmcnt(0)
    buffer_load_dwordx4 v4, s[44:47], s8 offen lds
    s_add_u32 m0, m0, 1056
    s_add_u32 s8, s8, 7680
    buffer_load_dwordx4 v4, s[44:47], s8 offen lds
    s_add_u32 m0, m0, 1056
    s_add_u32 s8, s8, 7680
    buffer_load_dwordx4 v4, s[44:47], s8 offen lds
    s_add_u32 m0, m0, 1056
    s_add_u32 s8, s8, 7680
    buffer_load_dwordx4 v4, s[44:47], s8 offen lds
L_npk0:
    s_barrier
L_comp2:
    s_load_dwordx2 s[52:53], s[0:1], 72
    s_mov_b32 s54, 2621440
    s_mov_b32 s55, 0x20000
    s_waitcnt lgkmcnt(0)
    s_load_dword s39, s[48:49], 0
    s_mov_b32 s3, 100000
    s_mov_b32 s50, 6946816
    s_mov_b32 s51, 0x20000
    s_mul_i32 s8, s30, 37
    s_lshr_b32 s8, s8, 8
    s_mul_i32 s9, s8, 7
    s_sub_u32 s37, s30, s9
    s_lshl_b32 s36, s29, 2
    s_add_u32 s36, s36, s8
    s_mul_i32 s4, s37, 96
    v_lshrrev_b32 v14, 4, v0
    v_and_b32 v15, 15, v0
    v_lshrrev_b32 v1, 1, v15
    v_xor_b32 v1, v1, v14
    v_lshlrev_b32 v1, 4, v1
    v_lshl_add_u32 v1, v15, 7, v1
    v_add_u32 v1, 61440, v1
    v_xor_b32 v2, 64, v1
    s_mul_i32 s6, s28, 40
    v_lshrrev_b32 v3, 2, v0
    v_mul_u32_u24 v3, 160, v3
    v_add_u32 v3, s6, v3
    v_and_b32 v12, 3, v0
    v_min_u32 v13, 2, v12
    v_mul_u32_u24 v13, 5120, v13
    v_add3_u32 v4, v3, v13, 32
    v_lshl_add_u32 v3, v12, 3, v3
    v_lshlrev_b32 v5, 4, v0
    v_mul_u32_u24 v6, 12, v14
    v_add_u32 v6, v6, v15
    v_lshlrev_b32 v6, 4, v6
    v_mov_b32 v13, 0x80000000
    v_cmp_gt_u32 vcc, 12, v15
    s_nop 1
    v_cndmask_b32 v6, v13, v6, vcc
    v_cndmask_b32 v7, 0, -1, vcc
    v_lshlrev_b32 v12, 2, v14
    v_sub_u32 v12, v15, v12
    v_mov_b32 v13, 0xf149f2ca
    v_subrev_u32 v254, 0, v12
    v_cmp_ge_u32 vcc, 7, v254
    s_nop 1
    v_cndmask_b32 v240, v13, 0, vcc
    v_cmp_ge_i32 vcc, -9, v254
    s_nop 1
    v_cndmask_b32 v244, v13, 0, vcc
    v_subrev_u32 v254, 1, v12
    v_cmp_ge_u32 vcc, 7, v254
    s_nop 1
    v_cndmask_b32 v241, v13, 0, vcc
    v_cmp_ge_i32 vcc, -9, v254
    s_nop 1
    v_cndmask_b32 v245, v13, 0, vcc
    v_subrev_u32 v254, 2, v12
    v_cmp_ge_u32 vcc, 7, v254
    s_nop 1
    v_cndmask_b32 v242, v13, 0, vcc
    v_cmp_ge_i32 vcc, -9, v254
    s_nop 1
    v_cndmask_b32 v246, v13, 0, vcc
    v_subrev_u32 v254, 3, v12
    v_cmp_ge_u32 vcc, 7, v254
    s_nop 1
    v_cndmask_b32 v243, v13, 0, vcc
    v_cmp_ge_i32 vcc, -9, v254
    s_nop 1
    v_cndmask_b32 v247, v13, 0, vcc
    v_mov_b32 v13, 0xffff
    v_cmp_le_i32 vcc, 0, v12
    s_nop 1
    v_cndmask_b32 v8, 0, v13, vcc
    v_cmp_le_i32 vcc, 1, v12
    s_nop 1
    v_cndmask_b32 v8, v8, -1, vcc
    v_not_b32 v10, v8
    v_cmp_le_i32 vcc, 2, v12
    s_nop 1
    v_cndmask_b32 v9, 0, v13, vcc
    v_cmp_le_i32 vcc, 3, v12
    s_nop 1
    v_cndmask_b32 v9, v9, -1, vcc
    v_not_b32 v11, v9
    v_and_b32 v12, 3, v0
    v_cmp_eq_u32 vcc, 1, v12
    s_nop 1
    v_cndmask_b32 v248, 0, 1.0, vcc
    v_cndmask_b32 v249, 0, 1.0, vcc
    v_cndmask_b32 v250, 0, 1.0, vcc
    v_cndmask_b32 v251, 0, 1.0, vcc
    v_mov_b32 v252, 0
    v_mov_b32 v253, 0
    s_mov_b32 s6, 0x3f80
    s_mov_b32 s7, 0x3f800000
    v_writelane_b32 v252, s6, 32
    v_writelane_b32 v252, s7, 36
    v_writelane_b32 v253, s6, 40
    v_writelane_b32 v253, s7, 44
    s_lshl_b32 s14, s32, 2
    s_add_u32 s14, s14, s28
    s_mul_i32 s15, s14, 3840
    s_add_u32 s15, s15, 3932160
    s_mov_b32 s16, 0x3ea52b5c
    s_mul_i32 s17, s34, 73
    s_add_u32 s18, s17, 7
    s_cmp_eq_u32 s34, 0
    s_cselect_b32 s18, 0, s18
    s_lshl_b32 s19, s33, 5
    s_add_u32 s6, s19, s14
    s_mul_i32 s22, s6, 33280
    s_add_u32 s22, s22, 262144
    s_mul_i32 s23, s6, 8320
    s_add_u32 s23, s23, 2392064
    s_mov_b32 s24, 16640
    s_mov_b32 s25, 0x80000000
    s_and_b32 s6, s36, 15
    s_lshl_b32 s6, s6, 6
    s_lshl_b32 s7, s28, 4
    s_add_u32 s26, s6, s7
    s_mul_i32 s6, s33, 1280
    s_lshl_b32 s7, s4, 1
    s_add_u32 s27, s6, s7
    s_cmp_eq_u32 s37, 6
    s_cselect_b32 s10, s25, 128
    s_mov_b32 s11, 5120
    s_mul_i32 s9, s33, 8448
    s_add_u32 s9, s9, 16384
    s_waitcnt lgkmcnt(0)
    s_mul_i32 s35, s39, 1664525
    s_add_u32 s35, s35, 1013904223
    v_cmp_eq_u32 vcc, 0, v0
    v_lshlrev_b32 v232, 2, v0
    s_nop 0
    v_cndmask_b32 v233, 0, 1, vcc
    s_cmp_ge_u32 s38, 24
    s_cbranch_scc1 L_npk1
    v_cmp_gt_u32 vcc, 48, v0
    s_mul_i32 s6, s28, 4224
    s_add_u32 s6, s6, 133120
    v_bfe_u32 v18, v0, 3, 1
    v_mul_u32_u24 v18, 1056, v18
    v_bfe_u32 v19, v0, 2, 1
    v_lshl_add_u32 v18, v19, 9, v18
    v_and_b32 v19, 3, v0
    v_lshrrev_b32 v20, 4, v0
    v_mul_u32_u24 v16, 160, v20
    v_lshl_add_u32 v16, v19, 3, v16
    v_min_u32 v19, 2, v19
    v_mul_u32_u24 v19, 160, v19
    v_add_u32 v19, 32, v19
    v_cndmask_b32 v16, v19, v16, vcc
    v_add3_u32 v16, v16, v18, s6
    v_mov_b32 v18, 192
    v_mov_b32 v19, 256
    v_cndmask_b32 v19, v18, v19, vcc
    s_and_b32 s6, s38, 1
    s_lshl_b32 s6, s6, 1
    s_add_u32 s6, s6, s28
    v_mul_u32_u24 v18, s6, v19
    v_lshl_add_u32 v18, v20, 10, v18
    v_lshl_add_u32 v18, v15, 4, v18
    v_cmp_gt_u32 vcc, 60, v0
    s_lshr_b32 s6, s38, 1
    s_lshl_b32 s6, s6, 3
    s_add_u32 s12, s32, s6
    v_cndmask_b32 v17, v17, v18, vcc
    s_mul_i32 s12, s12, 15360
    s_add_u32 s12, s12, 3932160
    s_waitcnt vmcnt(0)
    ds_read_b64_tr_b16 v[136:137], v16 offset:0
    ds_read_b64_tr_b16 v[138:139], v16 offset:2112
    ds_read_b64_tr_b16 v[140:141], v16 offset:40
    ds_read_b64_tr_b16 v[142:143], v16 offset:2152
    ds_read_b64_tr_b16 v[144:145], v16 offset:80
    ds_read_b64_tr_b16 v[146:147], v16 offset:2192
    ds_read_b64_tr_b16 v[148:149], v16 offset:120
    ds_read_b64_tr_b16 v[150:151], v16 offset:2232
    s_waitcnt lgkmcnt(6)
    buffer_store_dwordx4 v[136:139], v17, s[48:51], s12 offen sc1
    s_add_u32 s12, s12, 3840
    s_waitcnt lgkmcnt(4)
    buffer_store_dwordx4 v[140:143], v17, s[48:51], s12 offen sc1
    s_add_u32 s12, s12, 3840
    s_waitcnt lgkmcnt(2)
    buffer_store_dwordx4 v[144:147], v17, s[48:51], s12 offen sc1
    s_add_u32 s12, s12, 3840
    s_waitcnt lgkmcnt(0)
    buffer_store_dwordx4 v[148:151], v17, s[48:51], s12 offen sc1
    s_add_u32 s12, s12, 3840
    s_waitcnt lgkmcnt(0)
L_npk1:
    v_mov_b32 v234, v17
    s_setprio 2
    s_barrier
    ds_read_b128 v[96:99], v1 offset:0
    ds_read_b128 v[100:103], v1 offset:2048
    ds_read_b128 v[104:107], v1 offset:4096
    ds_read_b128 v[108:111], v1 offset:6144
    ds_read_b128 v[112:115], v1 offset:8192
    ds_read_b64_tr_b16 v[200:201], v3 offset:0
    ds_read_b64_tr_b16 v[202:203], v3 offset:2560
    ds_read_b64_tr_b16 v[204:205], v3 offset:5120
    ds_read_b64_tr_b16 v[206:207], v3 offset:7680
    ds_read_b64_tr_b16 v[208:209], v3 offset:10240
    ds_read_b64_tr_b16 v[210:211], v3 offset:12800
    ds_read_b64_tr_b16 v[212:213], v4 offset:0
    ds_read_b64_tr_b16 v[214:215], v4 offset:2560
    s_waitcnt lgkmcnt(6)
    v_mfma_f32_16x16x32_bf16 v[16:19], v[200:203], v[96:99], 0
    ds_read_b128 v[116:119], v2 offset:0
    v_mfma_f32_16x16x32_bf16 v[20:23], v[200:203], v[100:103], 0
    ds_read_b128 v[120:123], v2 offset:2048
    v_mfma_f32_16x16x32_bf16 v[24:27], v[200:203], v[104:107], 0
    ds_read_b128 v[124:127], v2 offset:4096
    v_mfma_f32_16x16x32_bf16 v[28:31], v[200:203], v[108:111], 0
    ds_read_b128 v[128:131], v2 offset:6144
    v_mfma_f32_16x16x32_bf16 v[32:35], v[200:203], v[112:115], 0
    ds_read_b128 v[132:135], v2 offset:8192
    s_waitcnt lgkmcnt(9)
    v_mfma_f32_16x16x32_bf16 v[36:39], v[204:207], v[96:99], 0
    v_mfma_f32_16x16x32_bf16 v[40:43], v[204:207], v[100:103], 0
    v_mfma_f32_16x16x32_bf16 v[44:47], v[204:207], v[104:107], 0
    v_mfma_f32_16x16x32_bf16 v[48:51], v[204:207], v[108:111], 0
    v_mfma_f32_16x16x32_bf16 v[52:55], v[204:207], v[112:115], 0
    s_waitcnt lgkmcnt(5)
    v_mfma_f32_16x16x32_bf16 v[56:59], v[96:99], v[208:211], 0
    v_and_b32 v212, v7, v212
    v_mfma_f32_16x16x32_bf16 v[60:63], v[100:103], v[208:211], 0
    v_and_b32 v213, v7, v213
    v_mfma_f32_16x16x32_bf16 v[64:67], v[104:107], v[208:211], 0
    v_and_b32 v214, v7, v214
    v_mfma_f32_16x16x32_bf16 v[68:71], v[108:111], v[208:211], 0
    v_and_b32 v215, v7, v215
    v_mfma_f32_16x16x32_bf16 v[72:75], v[112:115], v[208:211], 0
    s_waitcnt vmcnt(0)
    s_branch L_page
.p2align 12
L_page:
    s_barrier
    ds_read_b64_tr_b16 v[216:217], v3 offset:15360
    ds_read_b64_tr_b16 v[218:219], v3 offset:17920
    ds_read_b64_tr_b16 v[220:221], v3 offset:20480
    ds_read_b64_tr_b16 v[222:223], v3 offset:23040
    ds_read_b64_tr_b16 v[224:225], v3 offset:25600
    ds_read_b64_tr_b16 v[226:227], v3 offset:28160
    ds_read_b64_tr_b16 v[228:229], v4 offset:15360
    ds_read_b64_tr_b16 v[230:231], v4 offset:17920
    v_mfma_f32_16x16x32_bf16 v[76:79], v[212:215], v[96:99], 0
    v_mfma_f32_16x16x32_bf16 v[80:83], v[212:215], v[100:103], 0
    v_mfma_f32_16x16x32_bf16 v[84:87], v[212:215], v[104:107], 0
    v_mfma_f32_16x16x32_bf16 v[88:91], v[212:215], v[108:111], 0
    v_mfma_f32_16x16x32_bf16 v[92:95], v[212:215], v[112:115], 0
    s_waitcnt lgkmcnt(6)
    v_mfma_f32_16x16x32_bf16 v[16:19], v[216:219], v[116:119], v[16:19]
    ds_read_b128 v[96:99], v1 offset:10240
    v_mfma_f32_16x16x32_bf16 v[20:23], v[216:219], v[120:123], v[20:23]
    ds_read_b128 v[100:103], v1 offset:12288
    v_mfma_f32_16x16x32_bf16 v[24:27], v[216:219], v[124:127], v[24:27]
    ds_read_b128 v[104:107], v1 offset:14336
    v_mfma_f32_16x16x32_bf16 v[28:31], v[216:219], v[128:131], v[28:31]
    ds_read_b128 v[108:111], v1 offset:16384
    v_mfma_f32_16x16x32_bf16 v[32:35], v[216:219], v[132:135], v[32:35]
    ds_read_b128 v[112:115], v1 offset:18432
    s_waitcnt lgkmcnt(9)
    v_mfma_f32_16x16x32_bf16 v[36:39], v[220:223], v[116:119], v[36:39]
    v_mfma_f32_16x16x32_bf16 v[40:43], v[220:223], v[120:123], v[40:43]
    v_mfma_f32_16x16x32_bf16 v[44:47], v[220:223], v[124:127], v[44:47]
    v_mfma_f32_16x16x32_bf16 v[48:51], v[220:223], v[128:131], v[48:51]
    v_mfma_f32_16x16x32_bf16 v[52:55], v[220:223], v[132:135], v[52:55]
    s_waitcnt lgkmcnt(5)
    v_mfma_f32_16x16x32_bf16 v[56:59], v[116:119], v[224:227], v[56:59]
    v_and_b32 v228, v7, v228
    v_mfma_f32_16x16x32_bf16 v[60:63], v[120:123], v[224:227], v[60:63]
    v_and_b32 v229, v7, v229
    v_mfma_f32_16x16x32_bf16 v[64:67], v[124:127], v[224:227], v[64:67]
    v_and_b32 v230, v7, v230
    v_mfma_f32_16x16x32_bf16 v[68:71], v[128:131], v[224:227], v[68:71]
    v_and_b32 v231, v7, v231
    v_mfma_f32_16x16x32_bf16 v[72:75], v[132:135], v[224:227], v[72:75]
    s_barrier
    ds_read_b64_tr_b16 v[200:201], v3 offset:30720
    ds_read_b64_tr_b16 v[202:203], v3 offset:33280
    ds_read_b64_tr_b16 v[204:205], v3 offset:35840
    ds_read_b64_tr_b16 v[206:207], v3 offset:38400
    ds_read_b64_tr_b16 v[208:209], v3 offset:40960
    ds_read_b64_tr_b16 v[210:211], v3 offset:43520
    ds_read_b64_tr_b16 v[212:213], v4 offset:30720
    ds_read_b64_tr_b16 v[214:215], v4 offset:33280
    v_mfma_f32_16x16x32_bf16 v[76:79], v[228:231], v[116:119], v[76:79]
    v_mfma_f32_16x16x32_bf16 v[80:83], v[228:231], v[120:123], v[80:83]
    v_mfma_f32_16x16x32_bf16 v[84:87], v[228:231], v[124:127], v[84:87]
    v_mfma_f32_16x16x32_bf16 v[88:91], v[228:231], v[128:131], v[88:91]
    v_mfma_f32_16x16x32_bf16 v[92:95], v[228:231], v[132:135], v[92:95]
    s_waitcnt lgkmcnt(6)
    v_mfma_f32_16x16x32_bf16 v[16:19], v[200:203], v[96:99], v[16:19]
    ds_read_b128 v[116:119], v2 offset:10240
    v_mfma_f32_16x16x32_bf16 v[20:23], v[200:203], v[100:103], v[20:23]
    ds_read_b128 v[120:123], v2 offset:12288
    v_mfma_f32_16x16x32_bf16 v[24:27], v[200:203], v[104:107], v[24:27]
    ds_read_b128 v[124:127], v2 offset:14336
    v_mfma_f32_16x16x32_bf16 v[28:31], v[200:203], v[108:111], v[28:31]
    ds_read_b128 v[128:131], v2 offset:16384
    v_mfma_f32_16x16x32_bf16 v[32:35], v[200:203], v[112:115], v[32:35]
    ds_read_b128 v[132:135], v2 offset:18432
    s_waitcnt lgkmcnt(9)
    v_mfma_f32_16x16x32_bf16 v[36:39], v[204:207], v[96:99], v[36:39]
    v_mfma_f32_16x16x32_bf16 v[40:43], v[204:207], v[100:103], v[40:43]
    v_mfma_f32_16x16x32_bf16 v[44:47], v[204:207], v[104:107], v[44:47]
    v_mfma_f32_16x16x32_bf16 v[48:51], v[204:207], v[108:111], v[48:51]
    v_mfma_f32_16x16x32_bf16 v[52:55], v[204:207], v[112:115], v[52:55]
    s_waitcnt lgkmcnt(5)
    v_mfma_f32_16x16x32_bf16 v[56:59], v[96:99], v[208:211], v[56:59]
    v_and_b32 v212, v7, v212
    v_mfma_f32_16x16x32_bf16 v[60:63], v[100:103], v[208:211], v[60:63]
    v_and_b32 v213, v7, v213
    v_mfma_f32_16x16x32_bf16 v[64:67], v[104:107], v[208:211], v[64:67]
    v_and_b32 v214, v7, v214
    v_mfma_f32_16x16x32_bf16 v[68:71], v[108:111], v[208:211], v[68:71]
    v_and_b32 v215, v7, v215
    v_mfma_f32_16x16x32_bf16 v[72:75], v[112:115], v[208:211], v[72:75]
    s_barrier
    ds_read_b64_tr_b16 v[216:217], v3 offset:46080
    ds_read_b64_tr_b16 v[218:219], v3 offset:48640
    ds_read_b64_tr_b16 v[220:221], v3 offset:51200
    ds_read_b64_tr_b16 v[222:223], v3 offset:53760
    ds_read_b64_tr_b16 v[224:225], v3 offset:56320
    ds_read_b64_tr_b16 v[226:227], v3 offset:58880
    ds_read_b64_tr_b16 v[228:229], v4 offset:46080
    ds_read_b64_tr_b16 v[230:231], v4 offset:48640
    v_mfma_f32_16x16x32_bf16 v[76:79], v[212:215], v[96:99], v[76:79]
    v_mfma_f32_16x16x32_bf16 v[80:83], v[212:215], v[100:103], v[80:83]
    v_mfma_f32_16x16x32_bf16 v[84:87], v[212:215], v[104:107], v[84:87]
    v_mfma_f32_16x16x32_bf16 v[88:91], v[212:215], v[108:111], v[88:91]
    v_mfma_f32_16x16x32_bf16 v[92:95], v[212:215], v[112:115], v[92:95]
    s_waitcnt lgkmcnt(6)
    v_mfma_f32_16x16x32_bf16 v[16:19], v[216:219], v[116:119], v[16:19]
    ds_read_b128 v[96:99], v1 offset:20480
    v_mfma_f32_16x16x32_bf16 v[20:23], v[216:219], v[120:123], v[20:23]
    ds_read_b128 v[100:103], v1 offset:22528
    v_mfma_f32_16x16x32_bf16 v[24:27], v[216:219], v[124:127], v[24:27]
    ds_read_b128 v[104:107], v1 offset:24576
    v_mfma_f32_16x16x32_bf16 v[28:31], v[216:219], v[128:131], v[28:31]
    ds_read_b128 v[108:111], v1 offset:26624
    v_mfma_f32_16x16x32_bf16 v[32:35], v[216:219], v[132:135], v[32:35]
    ds_read_b128 v[112:115], v1 offset:28672
    s_waitcnt lgkmcnt(9)
    v_mfma_f32_16x16x32_bf16 v[36:39], v[220:223], v[116:119], v[36:39]
    v_mfma_f32_16x16x32_bf16 v[40:43], v[220:223], v[120:123], v[40:43]
    v_mfma_f32_16x16x32_bf16 v[44:47], v[220:223], v[124:127], v[44:47]
    v_mfma_f32_16x16x32_bf16 v[48:51], v[220:223], v[128:131], v[48:51]
    v_mfma_f32_16x16x32_bf16 v[52:55], v[220:223], v[132:135], v[52:55]
    s_waitcnt lgkmcnt(5)
    v_mfma_f32_16x16x32_bf16 v[56:59], v[116:119], v[224:227], v[56:59]
    v_and_b32 v228, v7, v228
    v_mfma_f32_16x16x32_bf16 v[60:63], v[120:123], v[224:227], v[60:63]
    v_and_b32 v229, v7, v229
    v_mfma_f32_16x16x32_bf16 v[64:67], v[124:127], v[224:227], v[64:67]
    v_and_b32 v230, v7, v230
    v_mfma_f32_16x16x32_bf16 v[68:71], v[128:131], v[224:227], v[68:71]
    v_and_b32 v231, v7, v231
    v_mfma_f32_16x16x32_bf16 v[72:75], v[132:135], v[224:227], v[72:75]
    s_barrier
    ds_read_b64_tr_b16 v[200:201], v3 offset:0
    ds_read_b64_tr_b16 v[202:203], v3 offset:2560
    ds_read_b64_tr_b16 v[204:205], v3 offset:5120
    ds_read_b64_tr_b16 v[206:207], v3 offset:7680
    ds_read_b64_tr_b16 v[208:209], v3 offset:10240
    ds_read_b64_tr_b16 v[210:211], v3 offset:12800
    ds_read_b64_tr_b16 v[212:213], v4 offset:0
    ds_read_b64_tr_b16 v[214:215], v4 offset:2560
    v_mfma_f32_16x16x32_bf16 v[76:79], v[228:231], v[116:119], v[76:79]
    v_mfma_f32_16x16x32_bf16 v[80:83], v[228:231], v[120:123], v[80:83]
    v_mfma_f32_16x16x32_bf16 v[84:87], v[228:231], v[124:127], v[84:87]
    v_mfma_f32_16x16x32_bf16 v[88:91], v[228:231], v[128:131], v[88:91]
    v_mfma_f32_16x16x32_bf16 v[92:95], v[228:231], v[132:135], v[92:95]
    s_waitcnt lgkmcnt(6)
    v_mfma_f32_16x16x32_bf16 v[16:19], v[200:203], v[96:99], v[16:19]
    ds_read_b128 v[116:119], v2 offset:20480
    v_mfma_f32_16x16x32_bf16 v[20:23], v[200:203], v[100:103], v[20:23]
    ds_read_b128 v[120:123], v2 offset:22528
    v_mfma_f32_16x16x32_bf16 v[24:27], v[200:203], v[104:107], v[24:27]
    ds_read_b128 v[124:127], v2 offset:24576
    v_mfma_f32_16x16x32_bf16 v[28:31], v[200:203], v[108:111], v[28:31]
    ds_read_b128 v[128:131], v2 offset:26624
    v_mfma_f32_16x16x32_bf16 v[32:35], v[200:203], v[112:115], v[32:35]
    ds_read_b128 v[132:135], v2 offset:28672
    s_waitcnt lgkmcnt(9)
    v_mfma_f32_16x16x32_bf16 v[36:39], v[204:207], v[96:99], v[36:39]
    v_mfma_f32_16x16x32_bf16 v[40:43], v[204:207], v[100:103], v[40:43]
    v_mfma_f32_16x16x32_bf16 v[44:47], v[204:207], v[104:107], v[44:47]
    v_mfma_f32_16x16x32_bf16 v[48:51], v[204:207], v[108:111], v[48:51]
    v_mfma_f32_16x16x32_bf16 v[52:55], v[204:207], v[112:115], v[52:55]
    s_waitcnt lgkmcnt(5)
    v_mfma_f32_16x16x32_bf16 v[56:59], v[96:99], v[208:211], v[56:59]
    v_and_b32 v212, v7, v212
    v_mfma_f32_16x16x32_bf16 v[60:63], v[100:103], v[208:211], v[60:63]
    v_and_b32 v213, v7, v213
    v_mfma_f32_16x16x32_bf16 v[64:67], v[104:107], v[208:211], v[64:67]
    v_and_b32 v214, v7, v214
    v_mfma_f32_16x16x32_bf16 v[68:71], v[108:111], v[208:211], v[68:71]
    v_and_b32 v215, v7, v215
    v_mfma_f32_16x16x32_bf16 v[72:75], v[112:115], v[208:211], v[72:75]
    s_barrier
    ds_read_b64_tr_b16 v[216:217], v3 offset:15360
    ds_read_b64_tr_b16 v[218:219], v3 offset:17920
    ds_read_b64_tr_b16 v[220:221], v3 offset:20480
    ds_read_b64_tr_b16 v[222:223], v3 offset:23040
    ds_read_b64_tr_b16 v[224:225], v3 offset:25600
    ds_read_b64_tr_b16 v[226:227], v3 offset:28160
    ds_read_b64_tr_b16 v[228:229], v4 offset:15360
    ds_read_b64_tr_b16 v[230:231], v4 offset:17920
    v_mfma_f32_16x16x32_bf16 v[76:79], v[212:215], v[96:99], v[76:79]
    v_mfma_f32_16x16x32_bf16 v[80:83], v[212:215], v[100:103], v[80:83]
    v_mfma_f32_16x16x32_bf16 v[84:87], v[212:215], v[104:107], v[84:87]
    v_mfma_f32_16x16x32_bf16 v[88:91], v[212:215], v[108:111], v[88:91]
    v_mfma_f32_16x16x32_bf16 v[92:95], v[212:215], v[112:115], v[92:95]
    s_waitcnt lgkmcnt(6)
    v_mfma_f32_16x16x32_bf16 v[16:19], v[216:219], v[116:119], v[16:19]
    ds_read_b128 v[96:99], v1 offset:30720
    v_mfma_f32_16x16x32_bf16 v[20:23], v[216:219], v[120:123], v[20:23]
    ds_read_b128 v[100:103], v1 offset:32768
    v_mfma_f32_16x16x32_bf16 v[24:27], v[216:219], v[124:127], v[24:27]
    ds_read_b128 v[104:107], v1 offset:34816
    v_mfma_f32_16x16x32_bf16 v[28:31], v[216:219], v[128:131], v[28:31]
    ds_read_b128 v[108:111], v1 offset:36864
    v_mfma_f32_16x16x32_bf16 v[32:35], v[216:219], v[132:135], v[32:35]
    ds_read_b128 v[112:115], v1 offset:38912
    s_waitcnt lgkmcnt(9)
    v_mfma_f32_16x16x32_bf16 v[36:39], v[220:223], v[116:119], v[36:39]
    v_mfma_f32_16x16x32_bf16 v[40:43], v[220:223], v[120:123], v[40:43]
    v_mfma_f32_16x16x32_bf16 v[44:47], v[220:223], v[124:127], v[44:47]
    v_mfma_f32_16x16x32_bf16 v[48:51], v[220:223], v[128:131], v[48:51]
    v_mfma_f32_16x16x32_bf16 v[52:55], v[220:223], v[132:135], v[52:55]
    s_waitcnt lgkmcnt(5)
    v_mfma_f32_16x16x32_bf16 v[56:59], v[116:119], v[224:227], v[56:59]
    v_and_b32 v228, v7, v228
    v_mfma_f32_16x16x32_bf16 v[60:63], v[120:123], v[224:227], v[60:63]
    v_and_b32 v229, v7, v229
    v_mfma_f32_16x16x32_bf16 v[64:67], v[124:127], v[224:227], v[64:67]
    v_and_b32 v230, v7, v230
    v_mfma_f32_16x16x32_bf16 v[68:71], v[128:131], v[224:227], v[68:71]
    v_and_b32 v231, v7, v231
    v_mfma_f32_16x16x32_bf16 v[72:75], v[132:135], v[224:227], v[72:75]
    s_barrier
    ds_read_b64_tr_b16 v[200:201], v3 offset:30720
    ds_read_b64_tr_b16 v[202:203], v3 offset:33280
    ds_read_b64_tr_b16 v[204:205], v3 offset:35840
    ds_read_b64_tr_b16 v[206:207], v3 offset:38400
    ds_read_b64_tr_b16 v[208:209], v3 offset:40960
    ds_read_b64_tr_b16 v[210:211], v3 offset:43520
    ds_read_b64_tr_b16 v[212:213], v4 offset:30720
    ds_read_b64_tr_b16 v[214:215], v4 offset:33280
    v_mfma_f32_16x16x32_bf16 v[76:79], v[228:231], v[116:119], v[76:79]
    v_mfma_f32_16x16x32_bf16 v[80:83], v[228:231], v[120:123], v[80:83]
    v_mfma_f32_16x16x32_bf16 v[84:87], v[228:231], v[124:127], v[84:87]
    v_mfma_f32_16x16x32_bf16 v[88:91], v[228:231], v[128:131], v[88:91]
    v_mfma_f32_16x16x32_bf16 v[92:95], v[228:231], v[132:135], v[92:95]
    s_waitcnt lgkmcnt(6)
    v_mfma_f32_16x16x32_bf16 v[16:19], v[200:203], v[96:99], v[16:19]
    ds_read_b128 v[116:119], v2 offset:30720
    v_mfma_f32_16x16x32_bf16 v[20:23], v[200:203], v[100:103], v[20:23]
    ds_read_b128 v[120:123], v2 offset:32768
    v_mfma_f32_16x16x32_bf16 v[24:27], v[200:203], v[104:107], v[24:27]
    ds_read_b128 v[124:127], v2 offset:34816
    v_mfma_f32_16x16x32_bf16 v[28:31], v[200:203], v[108:111], v[28:31]
    ds_read_b128 v[128:131], v2 offset:36864
    v_mfma_f32_16x16x32_bf16 v[32:35], v[200:203], v[112:115], v[32:35]
    ds_read_b128 v[132:135], v2 offset:38912
    s_waitcnt lgkmcnt(9)
    v_mfma_f32_16x16x32_bf16 v[36:39], v[204:207], v[96:99], v[36:39]
    buffer_load_dwordx4 v[136:139], v5, s[48:51], s15 offen offset:0 sc1
    v_mfma_f32_16x16x32_bf16 v[40:43], v[204:207], v[100:103], v[40:43]
    v_mfma_f32_16x16x32_bf16 v[44:47], v[204:207], v[104:107], v[44:47]
    buffer_load_dwordx4 v[140:143], v5, s[48:51], s15 offen offset:1024 sc1
    v_mfma_f32_16x16x32_bf16 v[48:51], v[204:207], v[108:111], v[48:51]
    v_mfma_f32_16x16x32_bf16 v[52:55], v[204:207], v[112:115], v[52:55]
    buffer_load_dwordx4 v[144:147], v5, s[48:51], s15 offen offset:2048 sc1
    s_waitcnt lgkmcnt(5)
    v_mfma_f32_16x16x32_bf16 v[56:59], v[96:99], v[208:211], v[56:59]
    v_and_b32 v212, v7, v212
    v_mfma_f32_16x16x32_bf16 v[60:63], v[100:103], v[208:211], v[60:63]
    v_and_b32 v213, v7, v213
    v_mfma_f32_16x16x32_bf16 v[64:67], v[104:107], v[208:211], v[64:67]
    v_and_b32 v214, v7, v214
    v_mfma_f32_16x16x32_bf16 v[68:71], v[108:111], v[208:211], v[68:71]
    v_and_b32 v215, v7, v215
    v_mfma_f32_16x16x32_bf16 v[72:75], v[112:115], v[208:211], v[72:75]
    buffer_load_dwordx4 v[148:151], v6, s[48:51], s15 offen offset:3072 sc1
    s_add_u32 s15, s15, 122880
    s_barrier
    ds_read_b64_tr_b16 v[216:217], v3 offset:46080
    ds_read_b64_tr_b16 v[218:219], v3 offset:48640
    ds_read_b64_tr_b16 v[220:221], v3 offset:51200
    ds_read_b64_tr_b16 v[222:223], v3 offset:53760
    ds_read_b64_tr_b16 v[224:225], v3 offset:56320
    ds_read_b64_tr_b16 v[226:227], v3 offset:58880
    ds_read_b64_tr_b16 v[228:229], v4 offset:46080
    ds_read_b64_tr_b16 v[230:231], v4 offset:48640
    v_mfma_f32_16x16x32_bf16 v[76:79], v[212:215], v[96:99], v[76:79]
    v_mfma_f32_16x16x32_bf16 v[80:83], v[212:215], v[100:103], v[80:83]
    v_mfma_f32_16x16x32_bf16 v[84:87], v[212:215], v[104:107], v[84:87]
    v_mfma_f32_16x16x32_bf16 v[88:91], v[212:215], v[108:111], v[88:91]
    v_mfma_f32_16x16x32_bf16 v[92:95], v[212:215], v[112:115], v[92:95]
    s_waitcnt lgkmcnt(6)
    v_mfma_f32_16x16x32_bf16 v[16:19], v[216:219], v[116:119], v[16:19]
    ds_read_b128 v[96:99], v1 offset:40960
    v_mfma_f32_16x16x32_bf16 v[20:23], v[216:219], v[120:123], v[20:23]
    ds_read_b128 v[100:103], v1 offset:43008
    v_mfma_f32_16x16x32_bf16 v[24:27], v[216:219], v[124:127], v[24:27]
    ds_read_b128 v[104:107], v1 offset:45056
    v_mfma_f32_16x16x32_bf16 v[28:31], v[216:219], v[128:131], v[28:31]
    ds_read_b128 v[108:111], v1 offset:47104
    v_mfma_f32_16x16x32_bf16 v[32:35], v[216:219], v[132:135], v[32:35]
    ds_read_b128 v[112:115], v1 offset:49152
    s_waitcnt lgkmcnt(9)
    v_mfma_f32_16x16x32_bf16 v[36:39], v[220:223], v[116:119], v[36:39]
    buffer_load_dwordx4 v[152:155], v5, s[48:51], s15 offen offset:0 sc1
    v_mfma_f32_16x16x32_bf16 v[40:43], v[220:223], v[120:123], v[40:43]
    v_mfma_f32_16x16x32_bf16 v[44:47], v[220:223], v[124:127], v[44:47]
    buffer_load_dwordx4 v[156:159], v5, s[48:51], s15 offen offset:1024 sc1
    v_mfma_f32_16x16x32_bf16 v[48:51], v[220:223], v[128:131], v[48:51]
    v_mfma_f32_16x16x32_bf16 v[52:55], v[220:223], v[132:135], v[52:55]
    buffer_load_dwordx4 v[160:163], v5, s[48:51], s15 offen offset:2048 sc1
    s_waitcnt lgkmcnt(5)
    v_mfma_f32_16x16x32_bf16 v[56:59], v[116:119], v[224:227], v[56:59]
    v_and_b32 v228, v7, v228
    v_mfma_f32_16x16x32_bf16 v[60:63], v[120:123], v[224:227], v[60:63]
    v_and_b32 v229, v7, v229
    v_mfma_f32_16x16x32_bf16 v[64:67], v[124:127], v[224:227], v[64:67]
    v_and_b32 v230, v7, v230
    v_mfma_f32_16x16x32_bf16 v[68:71], v[128:131], v[224:227], v[68:71]
    v_and_b32 v231, v7, v231
    v_mfma_f32_16x16x32_bf16 v[72:75], v[132:135], v[224:227], v[72:75]
    buffer_load_dwordx4 v[164:167], v6, s[48:51], s15 offen offset:3072 sc1
    s_add_u32 s15, s15, 122880
    v_mfma_f32_16x16x32_bf16 v[76:79], v[228:231], v[116:119], v[76:79]
    v_mfma_f32_16x16x32_bf16 v[80:83], v[228:231], v[120:123], v[80:83]
    v_mfma_f32_16x16x32_bf16 v[84:87], v[228:231], v[124:127], v[84:87]
    v_mfma_f32_16x16x32_bf16 v[88:91], v[228:231], v[128:131], v[88:91]
    v_mfma_f32_16x16x32_bf16 v[92:95], v[228:231], v[132:135], v[92:95]
    s_waitcnt vmcnt(7) lgkmcnt(0)
    v_mfma_f32_16x16x32_bf16 v[16:19], v[136:139], v[96:99], v[16:19]
    buffer_load_dwordx4 v[168:171], v5, s[48:51], s15 offen offset:0 sc1
    v_mfma_f32_16x16x32_bf16 v[20:23], v[136:139], v[100:103], v[20:23]
    ds_read_b128 v[116:119], v2 offset:40960
    v_mfma_f32_16x16x32_bf16 v[24:27], v[136:139], v[104:107], v[24:27]
    ds_read_b128 v[120:123], v2 offset:43008
    v_mfma_f32_16x16x32_bf16 v[28:31], v[136:139], v[108:111], v[28:31]
    ds_read_b128 v[124:127], v2 offset:45056
    v_mfma_f32_16x16x32_bf16 v[32:35], v[136:139], v[112:115], v[32:35]
    ds_read_b128 v[128:131], v2 offset:47104
    s_waitcnt vmcnt(7)
    v_mfma_f32_16x16x32_bf16 v[36:39], v[140:143], v[96:99], v[36:39]
    buffer_load_dwordx4 v[172:175], v5, s[48:51], s15 offen offset:1024 sc1
    v_mfma_f32_16x16x32_bf16 v[40:43], v[140:143], v[100:103], v[40:43]
    ds_read_b128 v[132:135], v2 offset:49152
    v_mfma_f32_16x16x32_bf16 v[44:47], v[140:143], v[104:107], v[44:47]
    v_and_b32 v254, 31, v0
    v_mfma_f32_16x16x32_bf16 v[48:51], v[140:143], v[108:111], v[48:51]
    v_add_u32 v254, s17, v254
    v_mfma_f32_16x16x32_bf16 v[52:55], v[140:143], v[112:115], v[52:55]
    v_lshl_add_u32 v3, v254, 4, s22
    s_waitcnt vmcnt(7)
    v_mfma_f32_16x16x32_bf16 v[56:59], v[96:99], v[144:147], v[56:59]
    buffer_load_dwordx4 v[176:179], v5, s[48:51], s15 offen offset:2048 sc1
    v_mfma_f32_16x16x32_bf16 v[60:63], v[100:103], v[144:147], v[60:63]
    v_lshrrev_b32 v7, 5, v0
    v_mfma_f32_16x16x32_bf16 v[64:67], v[104:107], v[144:147], v[64:67]
    v_mad_u32_u24 v4, v7, s24, v3
    v_mfma_f32_16x16x32_bf16 v[68:71], v[108:111], v[144:147], v[68:71]
    v_mov_b32 v255, s25
    v_mfma_f32_16x16x32_bf16 v[72:75], v[112:115], v[144:147], v[72:75]
    v_cmp_le_u32 vcc, s18, v254
    s_waitcnt vmcnt(7)
    v_mfma_f32_16x16x32_bf16 v[76:79], v[148:151], v[96:99], v[76:79]
    buffer_load_dwordx4 v[180:183], v6, s[48:51], s15 offen offset:3072 sc1
    v_mfma_f32_16x16x32_bf16 v[80:83], v[148:151], v[100:103], v[80:83]
    s_add_u32 s15, s15, 122880
    v_mfma_f32_16x16x32_bf16 v[84:87], v[148:151], v[104:107], v[84:87]
    buffer_load_dwordx4 v[184:187], v5, s[48:51], s15 offen offset:0 sc1
    v_mfma_f32_16x16x32_bf16 v[88:91], v[148:151], v[108:111], v[88:91]
    v_and_b32 v7, 16, v0
    v_mfma_f32_16x16x32_bf16 v[92:95], v[148:151], v[112:115], v[92:95]
    s_waitcnt vmcnt(8) lgkmcnt(0)
    s_barrier
    v_mfma_f32_16x16x32_bf16 v[16:19], v[152:155], v[116:119], v[16:19]
    buffer_load_dwordx4 v[188:191], v5, s[48:51], s15 offen offset:1024 sc1
    v_mfma_f32_16x16x32_bf16 v[20:23], v[152:155], v[120:123], v[20:23]
    v_add_u32 v1, 51200, v1
    v_mfma_f32_16x16x32_bf16 v[24:27], v[152:155], v[124:127], v[24:27]
    v_add_u32 v2, 51200, v2
    v_mfma_f32_16x16x32_bf16 v[28:31], v[152:155], v[128:131], v[28:31]
    ds_read_b128 v[96:99], v1 offset:0
    v_mfma_f32_16x16x32_bf16 v[32:35], v[152:155], v[132:135], v[32:35]
    ds_read_b128 v[100:103], v1 offset:2048
    s_waitcnt vmcnt(8)
    v_mfma_f32_16x16x32_bf16 v[36:39], v[156:159], v[116:119], v[36:39]
    buffer_load_dwordx4 v[192:195], v5, s[48:51], s15 offen offset:2048 sc1
    v_mfma_f32_16x16x32_bf16 v[40:43], v[156:159], v[120:123], v[40:43]
    ds_read_b128 v[104:107], v1 offset:4096
    v_mfma_f32_16x16x32_bf16 v[44:47], v[156:159], v[124:127], v[44:47]
    ds_read_b128 v[108:111], v1 offset:6144
    v_mfma_f32_16x16x32_bf16 v[48:51], v[156:159], v[128:131], v[48:51]
    ds_read_b128 v[112:115], v1 offset:8192
    v_mfma_f32_16x16x32_bf16 v[52:55], v[156:159], v[132:135], v[52:55]
    v_cndmask_b32 v3, v255, v4, vcc
    s_waitcnt vmcnt(8)
    v_mfma_f32_16x16x32_bf16 v[56:59], v[116:119], v[160:163], v[56:59]
    buffer_load_dwordx4 v[196:199], v6, s[48:51], s15 offen offset:3072 sc1
    v_mfma_f32_16x16x32_bf16 v[60:63], v[120:123], v[160:163], v[60:63]
    s_add_u32 s15, s15, 122880
    v_mfma_f32_16x16x32_bf16 v[64:67], v[124:127], v[160:163], v[64:67]
    v_lshl_add_u32 v254, v7, 8, v254
    v_mfma_f32_16x16x32_bf16 v[68:71], v[128:131], v[160:163], v[68:71]
    v_cmp_gt_u32 vcc, 960, v254
    v_mfma_f32_16x16x32_bf16 v[72:75], v[132:135], v[160:163], v[72:75]
    v_add_u32 v254, s17, v0
    s_waitcnt vmcnt(8)
    v_mfma_f32_16x16x32_bf16 v[76:79], v[164:167], v[116:119], v[76:79]
    buffer_load_dwordx4 v[200:203], v5, s[48:51], s15 offen offset:0 sc1
    v_mfma_f32_16x16x32_bf16 v[80:83], v[164:167], v[120:123], v[80:83]
    v_cndmask_b32 v7, v255, v4, vcc
    v_mfma_f32_16x16x32_bf16 v[84:87], v[164:167], v[124:127], v[84:87]
    buffer_load_dwordx4 v[204:207], v5, s[48:51], s15 offen offset:1024 sc1
    v_mfma_f32_16x16x32_bf16 v[88:91], v[164:167], v[128:131], v[88:91]
    v_lshl_add_u32 v13, v254, 3, s23
    v_mfma_f32_16x16x32_bf16 v[92:95], v[164:167], v[132:135], v[92:95]
    s_waitcnt vmcnt(6) lgkmcnt(0)
    v_mfma_f32_16x16x32_bf16 v[16:19], v[168:171], v[96:99], v[16:19]
    buffer_load_dwordx4 v[208:211], v5, s[48:51], s15 offen offset:2048 sc1
    v_mfma_f32_16x16x32_bf16 v[20:23], v[168:171], v[100:103], v[20:23]
    ds_read_b128 v[116:119], v2 offset:0
    v_mfma_f32_16x16x32_bf16 v[24:27], v[168:171], v[104:107], v[24:27]
    ds_read_b128 v[120:123], v2 offset:2048
    v_mfma_f32_16x16x32_bf16 v[28:31], v[168:171], v[108:111], v[28:31]
    ds_read_b128 v[124:127], v2 offset:4096
    v_mfma_f32_16x16x32_bf16 v[32:35], v[168:171], v[112:115], v[32:35]
    ds_read_b128 v[128:131], v2 offset:6144
    v_mfma_f32_16x16x32_bf16 v[36:39], v[172:175], v[96:99], v[36:39]
    buffer_load_dwordx4 v[212:215], v6, s[48:51], s15 offen offset:3072 sc1
    v_mfma_f32_16x16x32_bf16 v[40:43], v[172:175], v[100:103], v[40:43]
    s_add_u32 s15, s15, 122880
    v_mfma_f32_16x16x32_bf16 v[44:47], v[172:175], v[104:107], v[44:47]
    ds_read_b128 v[132:135], v2 offset:8192
    v_mfma_f32_16x16x32_bf16 v[48:51], v[172:175], v[108:111], v[48:51]
    v_cmp_le_u32 vcc, s18, v254
    v_mfma_f32_16x16x32_bf16 v[52:55], v[172:175], v[112:115], v[52:55]
    v_lshl_add_u32 v254, v14, 12, v254
    v_mfma_f32_16x16x32_bf16 v[56:59], v[96:99], v[176:179], v[56:59]
    buffer_load_dwordx4 v[216:219], v5, s[48:51], s15 offen offset:0 sc1
    v_mfma_f32_16x16x32_bf16 v[60:63], v[100:103], v[176:179], v[60:63]
    v_cndmask_b32 v12, v255, v13, vcc
    v_mfma_f32_16x16x32_bf16 v[64:67], v[104:107], v[176:179], v[64:67]
    v_cmp_gt_u32 vcc, 960, v254
    v_mfma_f32_16x16x32_bf16 v[68:71], v[108:111], v[176:179], v[68:71]
    s_nop 0
    v_cndmask_b32 v13, v255, v13, vcc
    v_mfma_f32_16x16x32_bf16 v[72:75], v[112:115], v[176:179], v[72:75]
    v_lshl_add_u32 v254, v14, 2, s26
    v_mfma_f32_16x16x32_bf16 v[76:79], v[180:183], v[96:99], v[76:79]
    buffer_load_dwordx4 v[220:223], v5, s[48:51], s15 offen offset:1024 sc1
    v_mfma_f32_16x16x32_bf16 v[80:83], v[180:183], v[100:103], v[80:83]
    v_mul_u32_u24 v14, 2560, v254
    v_mfma_f32_16x16x32_bf16 v[84:87], v[180:183], v[104:107], v[84:87]
    buffer_load_dwordx4 v[224:227], v5, s[48:51], s15 offen offset:2048 sc1
    v_mfma_f32_16x16x32_bf16 v[88:91], v[180:183], v[108:111], v[88:91]
    v_add_u32 v14, s27, v14
    v_mfma_f32_16x16x32_bf16 v[92:95], v[180:183], v[112:115], v[92:95]
    s_waitcnt vmcnt(7) lgkmcnt(0)
    v_mfma_f32_16x16x32_bf16 v[16:19], v[184:187], v[116:119], v[16:19]
    buffer_load_dwordx4 v[228:231], v6, s[48:51], s15 offen offset:3072 sc1
    v_mfma_f32_16x16x32_bf16 v[20:23], v[184:187], v[120:123], v[20:23]
    s_add_u32 s15, s15, 122880
    v_mfma_f32_16x16x32_bf16 v[24:27], v[184:187], v[124:127], v[24:27]
    ds_read_b128 v[96:99], v1 offset:10240
    v_mfma_f32_16x16x32_bf16 v[28:31], v[184:187], v[128:131], v[28:31]
    ds_read_b128 v[100:103], v1 offset:12288
    v_mfma_f32_16x16x32_bf16 v[32:35], v[184:187], v[132:135], v[32:35]
    ds_read_b128 v[104:107], v1 offset:14336
    v_mfma_f32_16x16x32_bf16 v[36:39], v[188:191], v[116:119], v[36:39]
    buffer_load_dwordx4 v[136:139], v5, s[48:51], s15 offen offset:0 sc1
    v_mfma_f32_16x16x32_bf16 v[40:43], v[188:191], v[120:123], v[40:43]
    ds_read_b128 v[108:111], v1 offset:16384
    v_mfma_f32_16x16x32_bf16 v[44:47], v[188:191], v[124:127], v[44:47]
    ds_read_b128 v[112:115], v1 offset:18432
    v_mfma_f32_16x16x32_bf16 v[48:51], v[188:191], v[128:131], v[48:51]
    ds_add_u32 v232, v233 offset:20
    v_mfma_f32_16x16x32_bf16 v[52:55], v[188:191], v[132:135], v[52:55]
    v_lshl_add_u32 v254, v254, 3, s9
    v_mfma_f32_16x16x32_bf16 v[56:59], v[116:119], v[192:195], v[56:59]
    buffer_load_dwordx4 v[140:143], v5, s[48:51], s15 offen offset:1024 sc1
    v_mfma_f32_16x16x32_bf16 v[60:63], v[120:123], v[192:195], v[60:63]
    v_lshl_add_u32 v14, v15, 3, v14
    v_mfma_f32_16x16x32_bf16 v[64:67], v[124:127], v[192:195], v[64:67]
    v_mfma_f32_16x16x32_bf16 v[68:71], v[128:131], v[192:195], v[68:71]
    v_mfma_f32_16x16x32_bf16 v[72:75], v[132:135], v[192:195], v[72:75]
    v_mfma_f32_16x16x32_bf16 v[76:79], v[196:199], v[116:119], v[76:79]
    buffer_load_dwordx4 v[144:147], v5, s[48:51], s15 offen offset:2048 sc1
    v_mfma_f32_16x16x32_bf16 v[80:83], v[196:199], v[120:123], v[80:83]
    v_mfma_f32_16x16x32_bf16 v[84:87], v[196:199], v[124:127], v[84:87]
    buffer_load_dwordx4 v[148:151], v6, s[48:51], s15 offen offset:3072 sc1
    v_mfma_f32_16x16x32_bf16 v[88:91], v[196:199], v[128:131], v[88:91]
    s_add_u32 s15, s15, 122880
    v_mfma_f32_16x16x32_bf16 v[92:95], v[196:199], v[132:135], v[92:95]
    s_waitcnt vmcnt(8) lgkmcnt(0)
    v_mfma_f32_16x16x32_bf16 v[16:19], v[200:203], v[96:99], v[16:19]
    buffer_load_dwordx4 v[152:155], v5, s[48:51], s15 offen offset:0 sc1
    v_mfma_f32_16x16x32_bf16 v[20:23], v[200:203], v[100:103], v[20:23]
    ds_read_b128 v[116:119], v2 offset:10240
    v_mfma_f32_16x16x32_bf16 v[24:27], v[200:203], v[104:107], v[24:27]
    ds_read_b128 v[120:123], v2 offset:12288
    v_mfma_f32_16x16x32_bf16 v[28:31], v[200:203], v[108:111], v[28:31]
    ds_read_b128 v[124:127], v2 offset:14336
    v_mfma_f32_16x16x32_bf16 v[32:35], v[200:203], v[112:115], v[32:35]
    ds_read_b128 v[128:131], v2 offset:16384
    v_mfma_f32_16x16x32_bf16 v[36:39], v[204:207], v[96:99], v[36:39]
    buffer_load_dwordx4 v[156:159], v5, s[48:51], s15 offen offset:1024 sc1
    v_mfma_f32_16x16x32_bf16 v[40:43], v[204:207], v[100:103], v[40:43]
    ds_read_b128 v[132:135], v2 offset:18432
    v_mfma_f32_16x16x32_bf16 v[44:47], v[204:207], v[104:107], v[44:47]
    v_mfma_f32_16x16x32_bf16 v[48:51], v[204:207], v[108:111], v[48:51]
    v_mfma_f32_16x16x32_bf16 v[52:55], v[204:207], v[112:115], v[52:55]
    v_mfma_f32_16x16x32_bf16 v[56:59], v[96:99], v[208:211], v[56:59]
    buffer_load_dwordx4 v[160:163], v5, s[48:51], s15 offen offset:2048 sc1
    v_mfma_f32_16x16x32_bf16 v[60:63], v[100:103], v[208:211], v[60:63]
    v_mfma_f32_16x16x32_bf16 v[64:67], v[104:107], v[208:211], v[64:67]
    v_mfma_f32_16x16x32_bf16 v[68:71], v[108:111], v[208:211], v[68:71]
    v_mfma_f32_16x16x32_bf16 v[72:75], v[112:115], v[208:211], v[72:75]
    v_mfma_f32_16x16x32_bf16 v[76:79], v[212:215], v[96:99], v[76:79]
    buffer_load_dwordx4 v[164:167], v6, s[48:51], s15 offen offset:3072 sc1
    v_mfma_f32_16x16x32_bf16 v[80:83], v[212:215], v[100:103], v[80:83]
    s_add_u32 s15, s15, 122880
    v_mfma_f32_16x16x32_bf16 v[84:87], v[212:215], v[104:107], v[84:87]
    buffer_load_dwordx4 v[168:171], v5, s[48:51], s15 offen offset:0 sc1
    v_mfma_f32_16x16x32_bf16 v[88:91], v[212:215], v[108:111], v[88:91]
    v_mfma_f32_16x16x32_bf16 v[92:95], v[212:215], v[112:115], v[92:95]
    s_waitcnt vmcnt(9) lgkmcnt(0)
    v_mfma_f32_16x16x32_bf16 v[16:19], v[216:219], v[116:119], v[16:19]
    buffer_load_dwordx4 v[172:175], v5, s[48:51], s15 offen offset:1024 sc1
    v_mfma_f32_16x16x32_bf16 v[20:23], v[216:219], v[120:123], v[20:23]
    ds_read_b128 v[96:99], v1 offset:20480
    v_mfma_f32_16x16x32_bf16 v[24:27], v[216:219], v[124:127], v[24:27]
    ds_read_b128 v[100:103], v1 offset:22528
    v_mfma_f32_16x16x32_bf16 v[28:31], v[216:219], v[128:131], v[28:31]
    ds_read_b128 v[104:107], v1 offset:24576
    v_mfma_f32_16x16x32_bf16 v[32:35], v[216:219], v[132:135], v[32:35]
    ds_read_b128 v[108:111], v1 offset:26624
    v_mfma_f32_16x16x32_bf16 v[36:39], v[220:223], v[116:119], v[36:39]
    buffer_load_dwordx4 v[176:179], v5, s[48:51], s15 offen offset:2048 sc1
    v_mfma_f32_16x16x32_bf16 v[40:43], v[220:223], v[120:123], v[40:43]
    ds_read_b128 v[112:115], v1 offset:28672
    v_mfma_f32_16x16x32_bf16 v[44:47], v[220:223], v[124:127], v[44:47]
    v_mfma_f32_16x16x32_bf16 v[48:51], v[220:223], v[128:131], v[48:51]
    v_mfma_f32_16x16x32_bf16 v[52:55], v[220:223], v[132:135], v[52:55]
    v_mfma_f32_16x16x32_bf16 v[56:59], v[116:119], v[224:227], v[56:59]
    buffer_load_dwordx4 v[180:183], v6, s[48:51], s15 offen offset:3072 sc1
    v_mfma_f32_16x16x32_bf16 v[60:63], v[120:123], v[224:227], v[60:63]
    s_add_u32 s15, s15, 122880
    v_mfma_f32_16x16x32_bf16 v[64:67], v[124:127], v[224:227], v[64:67]
    v_mfma_f32_16x16x32_bf16 v[68:71], v[128:131], v[224:227], v[68:71]
    v_mfma_f32_16x16x32_bf16 v[72:75], v[132:135], v[224:227], v[72:75]
    v_mfma_f32_16x16x32_bf16 v[76:79], v[228:231], v[116:119], v[76:79]
    buffer_load_dwordx4 v[184:187], v5, s[48:51], s15 offen offset:0 sc1
    v_mfma_f32_16x16x32_bf16 v[80:83], v[228:231], v[120:123], v[80:83]
    v_mfma_f32_16x16x32_bf16 v[84:87], v[228:231], v[124:127], v[84:87]
    buffer_load_dwordx4 v[188:191], v5, s[48:51], s15 offen offset:1024 sc1
    v_mfma_f32_16x16x32_bf16 v[88:91], v[228:231], v[128:131], v[88:91]
    v_mfma_f32_16x16x32_bf16 v[92:95], v[228:231], v[132:135], v[92:95]
    s_waitcnt vmcnt(10) lgkmcnt(0)
    v_mfma_f32_16x16x32_bf16 v[16:19], v[136:139], v[96:99], v[16:19]
    buffer_load_dwordx4 v[192:195], v5, s[48:51], s15 offen offset:2048 sc1
    v_mfma_f32_16x16x32_bf16 v[20:23], v[136:139], v[100:103], v[20:23]
    ds_read_b128 v[116:119], v2 offset:20480
    v_mfma_f32_16x16x32_bf16 v[24:27], v[136:139], v[104:107], v[24:27]
    ds_read_b128 v[120:123], v2 offset:22528
    v_mfma_f32_16x16x32_bf16 v[28:31], v[136:139], v[108:111], v[28:31]
    ds_read_b128 v[124:127], v2 offset:24576
    v_mfma_f32_16x16x32_bf16 v[32:35], v[136:139], v[112:115], v[32:35]
    ds_read_b128 v[128:131], v2 offset:26624
    v_mfma_f32_16x16x32_bf16 v[36:39], v[140:143], v[96:99], v[36:39]
    buffer_load_dwordx4 v[196:199], v6, s[48:51], s15 offen offset:3072 sc1
    v_mfma_f32_16x16x32_bf16 v[40:43], v[140:143], v[100:103], v[40:43]
    s_add_u32 s15, s15, 122880
    v_mfma_f32_16x16x32_bf16 v[44:47], v[140:143], v[104:107], v[44:47]
    ds_read_b128 v[132:135], v2 offset:28672
    v_mfma_f32_16x16x32_bf16 v[48:51], v[140:143], v[108:111], v[48:51]
    v_mfma_f32_16x16x32_bf16 v[52:55], v[140:143], v[112:115], v[52:55]
    v_mfma_f32_16x16x32_bf16 v[56:59], v[96:99], v[144:147], v[56:59]
    buffer_load_dwordx4 v[200:203], v5, s[48:51], s15 offen offset:0 sc1
    v_mfma_f32_16x16x32_bf16 v[60:63], v[100:103], v[144:147], v[60:63]
    v_mfma_f32_16x16x32_bf16 v[64:67], v[104:107], v[144:147], v[64:67]
    v_mfma_f32_16x16x32_bf16 v[68:71], v[108:111], v[144:147], v[68:71]
L_touch1:
    s_cbranch_execz L_touch2
    v_mfma_f32_16x16x32_bf16 v[72:75], v[112:115], v[144:147], v[72:75]
    v_mfma_f32_16x16x32_bf16 v[76:79], v[148:151], v[96:99], v[76:79]
    buffer_load_dwordx4 v[204:207], v5, s[48:51], s15 offen offset:1024 sc1
    v_mfma_f32_16x16x32_bf16 v[80:83], v[148:151], v[100:103], v[80:83]
    v_mfma_f32_16x16x32_bf16 v[84:87], v[148:151], v[104:107], v[84:87]
    buffer_load_dwordx4 v[208:211], v5, s[48:51], s15 offen offset:2048 sc1
    v_mfma_f32_16x16x32_bf16 v[88:91], v[148:151], v[108:111], v[88:91]
    v_mfma_f32_16x16x32_bf16 v[92:95], v[148:151], v[112:115], v[92:95]
    s_waitcnt vmcnt(11) lgkmcnt(0)
    v_mfma_f32_16x16x32_bf16 v[16:19], v[152:155], v[116:119], v[16:19]
    buffer_load_dwordx4 v[212:215], v6, s[48:51], s15 offen offset:3072 sc1
    v_mfma_f32_16x16x32_bf16 v[20:23], v[152:155], v[120:123], v[20:23]
    s_add_u32 s15, s15, 122880
    v_mfma_f32_16x16x32_bf16 v[24:27], v[152:155], v[124:127], v[24:27]
    ds_read_b128 v[96:99], v1 offset:30720
    v_mfma_f32_16x16x32_bf16 v[28:31], v[152:155], v[128:131], v[28:31]
    ds_read_b128 v[100:103], v1 offset:32768
    v_mfma_f32_16x16x32_bf16 v[32:35], v[152:155], v[132:135], v[32:35]
    ds_read_b128 v[104:107], v1 offset:34816
    v_mfma_f32_16x16x32_bf16 v[36:39], v[156:159], v[116:119], v[36:39]
    buffer_load_dwordx4 v[216:219], v5, s[48:51], s15 offen offset:0 sc1
    v_mfma_f32_16x16x32_bf16 v[40:43], v[156:159], v[120:123], v[40:43]
    ds_read_b128 v[108:111], v1 offset:36864
    v_mfma_f32_16x16x32_bf16 v[44:47], v[156:159], v[124:127], v[44:47]
    ds_read_b128 v[112:115], v1 offset:38912
    v_mfma_f32_16x16x32_bf16 v[48:51], v[156:159], v[128:131], v[48:51]
    ds_add_u32 v232, v233 offset:8
    v_mfma_f32_16x16x32_bf16 v[52:55], v[156:159], v[132:135], v[52:55]
    v_mfma_f32_16x16x32_bf16 v[56:59], v[116:119], v[160:163], v[56:59]
    buffer_load_dwordx4 v[220:223], v5, s[48:51], s15 offen offset:1024 sc1
    v_mfma_f32_16x16x32_bf16 v[60:63], v[120:123], v[160:163], v[60:63]
    v_mfma_f32_16x16x32_bf16 v[64:67], v[124:127], v[160:163], v[64:67]
    v_mfma_f32_16x16x32_bf16 v[68:71], v[128:131], v[160:163], v[68:71]
    v_mfma_f32_16x16x32_bf16 v[72:75], v[132:135], v[160:163], v[72:75]
    v_mfma_f32_16x16x32_bf16 v[76:79], v[164:167], v[116:119], v[76:79]
    buffer_load_dwordx4 v[224:227], v5, s[48:51], s15 offen offset:2048 sc1
    v_mfma_f32_16x16x32_bf16 v[80:83], v[164:167], v[120:123], v[80:83]
    v_mfma_f32_16x16x32_bf16 v[84:87], v[164:167], v[124:127], v[84:87]
    buffer_load_dwordx4 v[228:231], v6, s[48:51], s15 offen offset:3072 sc1
    v_mfma_f32_16x16x32_bf16 v[88:91], v[164:167], v[128:131], v[88:91]
    v_mfma_f32_16x16x32_bf16 v[92:95], v[164:167], v[132:135], v[92:95]
    s_waitcnt vmcnt(12) lgkmcnt(0)
    v_mfma_f32_16x16x32_bf16 v[16:19], v[168:171], v[96:99], v[16:19]
    ds_read_b128 v[116:119], v2 offset:30720
    v_mfma_f32_16x16x32_bf16 v[20:23], v[168:171], v[100:103], v[20:23]
    ds_read_b128 v[120:123], v2 offset:32768
    v_mfma_f32_16x16x32_bf16 v[24:27], v[168:171], v[104:107], v[24:27]
    ds_read_b128 v[124:127], v2 offset:34816
    v_mfma_f32_16x16x32_bf16 v[28:31], v[168:171], v[108:111], v[28:31]
    ds_read_b128 v[128:131], v2 offset:36864
    v_mfma_f32_16x16x32_bf16 v[32:35], v[168:171], v[112:115], v[32:35]
    ds_read_b128 v[132:135], v2 offset:38912
    v_mfma_f32_16x16x32_bf16 v[36:39], v[172:175], v[96:99], v[36:39]
    v_mfma_f32_16x16x32_bf16 v[40:43], v[172:175], v[100:103], v[40:43]
    v_mfma_f32_16x16x32_bf16 v[44:47], v[172:175], v[104:107], v[44:47]
    v_mfma_f32_16x16x32_bf16 v[48:51], v[172:175], v[108:111], v[48:51]
    v_mfma_f32_16x16x32_bf16 v[52:55], v[172:175], v[112:115], v[52:55]
    v_mfma_f32_16x16x32_bf16 v[56:59], v[96:99], v[176:179], v[56:59]
    v_mfma_f32_16x16x32_bf16 v[60:63], v[100:103], v[176:179], v[60:63]
    v_mfma_f32_16x16x32_bf16 v[64:67], v[104:107], v[176:179], v[64:67]
    v_mfma_f32_16x16x32_bf16 v[68:71], v[108:111], v[176:179], v[68:71]
    v_mfma_f32_16x16x32_bf16 v[72:75], v[112:115], v[176:179], v[72:75]
    v_mfma_f32_16x16x32_bf16 v[76:79], v[180:183], v[96:99], v[76:79]
    v_mfma_f32_16x16x32_bf16 v[80:83], v[180:183], v[100:103], v[80:83]
    v_mfma_f32_16x16x32_bf16 v[84:87], v[180:183], v[104:107], v[84:87]
    v_mfma_f32_16x16x32_bf16 v[88:91], v[180:183], v[108:111], v[88:91]
    v_mfma_f32_16x16x32_bf16 v[92:95], v[180:183], v[112:115], v[92:95]
    s_waitcnt vmcnt(8) lgkmcnt(0)
    v_mfma_f32_16x16x32_bf16 v[16:19], v[184:187], v[116:119], v[16:19]
    ds_read_b128 v[96:99], v1 offset:40960
    v_mfma_f32_16x16x32_bf16 v[20:23], v[184:187], v[120:123], v[20:23]
    ds_read_b128 v[100:103], v1 offset:43008
    v_mfma_f32_16x16x32_bf16 v[24:27], v[184:187], v[124:127], v[24:27]
    ds_read_b128 v[104:107], v1 offset:45056
    v_mfma_f32_16x16x32_bf16 v[28:31], v[184:187], v[128:131], v[28:31]
    ds_read_b128 v[108:111], v1 offset:47104
    v_mfma_f32_16x16x32_bf16 v[32:35], v[184:187], v[132:135], v[32:35]
    ds_read_b128 v[112:115], v1 offset:49152
    v_mfma_f32_16x16x32_bf16 v[36:39], v[188:191], v[116:119], v[36:39]
    v_mov_b32 v154, 0
    v_mfma_f32_16x16x32_bf16 v[40:43], v[188:191], v[120:123], v[40:43]
    v_mov_b32 v155, 0
    v_mfma_f32_16x16x32_bf16 v[44:47], v[188:191], v[124:127], v[44:47]
    v_mov_b32 v158, 0
    v_mfma_f32_16x16x32_bf16 v[48:51], v[188:191], v[128:131], v[48:51]
    v_mov_b32 v159, 0
    v_mfma_f32_16x16x32_bf16 v[52:55], v[188:191], v[132:135], v[52:55]
    v_mov_b32 v162, 0
    v_mfma_f32_16x16x32_bf16 v[56:59], v[116:119], v[192:195], v[56:59]
    v_mov_b32 v163, 0
    v_mfma_f32_16x16x32_bf16 v[60:63], v[120:123], v[192:195], v[60:63]
    v_mov_b32 v166, 0
    v_mfma_f32_16x16x32_bf16 v[64:67], v[124:127], v[192:195], v[64:67]
    v_mov_b32 v167, 0
    v_mfma_f32_16x16x32_bf16 v[68:71], v[128:131], v[192:195], v[68:71]
    v_mov_b32 v170, 0
    v_mfma_f32_16x16x32_bf16 v[72:75], v[132:135], v[192:195], v[72:75]
    v_mov_b32 v171, 0
    v_mfma_f32_16x16x32_bf16 v[76:79], v[196:199], v[116:119], v[76:79]
    v_mfma_f32_16x16x32_bf16 v[80:83], v[196:199], v[120:123], v[80:83]
    v_mfma_f32_16x16x32_bf16 v[84:87], v[196:199], v[124:127], v[84:87]
    v_mfma_f32_16x16x32_bf16 v[88:91], v[196:199], v[128:131], v[88:91]
    v_mfma_f32_16x16x32_bf16 v[92:95], v[196:199], v[132:135], v[92:95]
    s_waitcnt vmcnt(4) lgkmcnt(0)
    v_mfma_f32_16x16x32_bf16 v[16:19], v[200:203], v[96:99], v[16:19]
    ds_read_b128 v[116:119], v2 offset:40960
    v_mfma_f32_16x16x32_bf16 v[20:23], v[200:203], v[100:103], v[20:23]
    ds_read_b128 v[120:123], v2 offset:43008
    v_mfma_f32_16x16x32_bf16 v[24:27], v[200:203], v[104:107], v[24:27]
    ds_read_b128 v[124:127], v2 offset:45056
    v_mfma_f32_16x16x32_bf16 v[28:31], v[200:203], v[108:111], v[28:31]
    ds_read_b128 v[128:131], v2 offset:47104
    v_mfma_f32_16x16x32_bf16 v[32:35], v[200:203], v[112:115], v[32:35]
    ds_read_b128 v[132:135], v2 offset:49152
    v_mfma_f32_16x16x32_bf16 v[36:39], v[204:207], v[96:99], v[36:39]
    v_mfma_f32_16x16x32_bf16 v[40:43], v[204:207], v[100:103], v[40:43]
    v_mfma_f32_16x16x32_bf16 v[44:47], v[204:207], v[104:107], v[44:47]
    v_mfma_f32_16x16x32_bf16 v[48:51], v[204:207], v[108:111], v[48:51]
    v_mfma_f32_16x16x32_bf16 v[52:55], v[204:207], v[112:115], v[52:55]
    v_mfma_f32_16x16x32_bf16 v[76:79], v[212:215], v[96:99], v[76:79]
    v_mfma_f32_16x16x32_bf16 v[80:83], v[212:215], v[100:103], v[80:83]
    v_mfma_f32_16x16x32_bf16 v[84:87], v[212:215], v[104:107], v[84:87]
    v_mfma_f32_16x16x32_bf16 v[88:91], v[212:215], v[108:111], v[88:91]
    v_mfma_f32_16x16x32_bf16 v[92:95], v[212:215], v[112:115], v[92:95]
    s_waitcnt vmcnt(0) lgkmcnt(0)
    v_mfma_f32_16x16x32_bf16 v[76:79], v[228:231], v[116:119], v[76:79]
    v_mfma_f32_16x16x32_bf16 v[80:83], v[228:231], v[120:123], v[80:83]
    v_mfma_f32_16x16x32_bf16 v[84:87], v[228:231], v[124:127], v[84:87]
    v_mfma_f32_16x16x32_bf16 v[88:91], v[228:231], v[128:131], v[88:91]
    v_mfma_f32_16x16x32_bf16 v[92:95], v[228:231], v[132:135], v[92:95]
    v_mfma_f32_16x16x32_bf16 v[16:19], v[216:219], v[116:119], v[16:19]
    s_nop 2
    v_cvt_pk_bf16_f32 v174, v76, v77
    v_cvt_pk_bf16_f32 v175, v78, v79
    v_mfma_f32_16x16x32_bf16 v[20:23], v[216:219], v[120:123], v[20:23]
    v_cvt_pk_bf16_f32 v178, v80, v81
    v_cvt_pk_bf16_f32 v179, v82, v83
    v_mfma_f32_16x16x32_bf16 v[24:27], v[216:219], v[124:127], v[24:27]
    v_cvt_pk_bf16_f32 v182, v84, v85
    v_cvt_pk_bf16_f32 v183, v86, v87
    v_mfma_f32_16x16x32_bf16 v[28:31], v[216:219], v[128:131], v[28:31]
    v_cvt_pk_bf16_f32 v186, v88, v89
    v_cvt_pk_bf16_f32 v187, v90, v91
    v_mfma_f32_16x16x32_bf16 v[32:35], v[216:219], v[132:135], v[32:35]
    v_cvt_pk_bf16_f32 v190, v92, v93
    v_cvt_pk_bf16_f32 v191, v94, v95
    v_mfma_f32_16x16x32_bf16 v[36:39], v[220:223], v[116:119], v[36:39]
    v_cvt_pk_bf16_f32 v172, v16, v17
    v_cvt_pk_bf16_f32 v173, v18, v19
    v_mfma_f32_16x16x32_bf16 v[40:43], v[220:223], v[120:123], v[40:43]
    v_cvt_pk_bf16_f32 v176, v20, v21
    v_cvt_pk_bf16_f32 v177, v22, v23
    v_mfma_f32_16x16x32_bf16 v[44:47], v[220:223], v[124:127], v[44:47]
    v_cvt_pk_bf16_f32 v180, v24, v25
    v_cvt_pk_bf16_f32 v181, v26, v27
    v_mfma_f32_16x16x32_bf16 v[48:51], v[220:223], v[128:131], v[48:51]
    v_cvt_pk_bf16_f32 v184, v28, v29
    v_cvt_pk_bf16_f32 v185, v30, v31
    v_mfma_f32_16x16x32_bf16 v[52:55], v[220:223], v[132:135], v[52:55]
    v_cvt_pk_bf16_f32 v188, v32, v33
    v_cvt_pk_bf16_f32 v189, v34, v35
    v_mfma_f32_16x16x32_bf16 v[56:59], v[96:99], v[208:211], v[56:59]
    v_cvt_pk_bf16_f32 v152, v36, v37
    v_cvt_pk_bf16_f32 v153, v38, v39
    v_mfma_f32_16x16x32_bf16 v[60:63], v[100:103], v[208:211], v[60:63]
    v_cvt_pk_bf16_f32 v156, v40, v41
    v_cvt_pk_bf16_f32 v157, v42, v43
    v_mfma_f32_16x16x32_bf16 v[64:67], v[104:107], v[208:211], v[64:67]
    v_cvt_pk_bf16_f32 v160, v44, v45
    v_cvt_pk_bf16_f32 v161, v46, v47
    v_mfma_f32_16x16x32_bf16 v[68:71], v[108:111], v[208:211], v[68:71]
    v_cvt_pk_bf16_f32 v164, v48, v49
    v_cvt_pk_bf16_f32 v165, v50, v51
    v_mfma_f32_16x16x32_bf16 v[72:75], v[112:115], v[208:211], v[72:75]
    v_cvt_pk_bf16_f32 v168, v52, v53
    v_cvt_pk_bf16_f32 v169, v54, v55
    v_mfma_f32_16x16x32_bf16 v[56:59], v[116:119], v[224:227], v[56:59]
    v_permlane16_swap_b32 v174, v154
    v_mfma_f32_16x16x32_bf16 v[60:63], v[120:123], v[224:227], v[60:63]
    v_permlane16_swap_b32 v175, v155
    v_mfma_f32_16x16x32_bf16 v[64:67], v[124:127], v[224:227], v[64:67]
    v_permlane16_swap_b32 v178, v158
    v_mfma_f32_16x16x32_bf16 v[68:71], v[128:131], v[224:227], v[68:71]
    v_permlane16_swap_b32 v179, v159
    v_mfma_f32_16x16x32_bf16 v[72:75], v[132:135], v[224:227], v[72:75]
    v_permlane16_swap_b32 v182, v162
    v_mfma_f32_16x16x32_bf16 v[16:19], v[152:155], v[172:175], v[240:243]
    v_permlane16_swap_b32 v183, v163
    v_mfma_f32_16x16x32_bf16 v[20:23], v[156:159], v[176:179], v[240:243]
    v_permlane16_swap_b32 v186, v166
    v_mfma_f32_16x16x32_bf16 v[40:43], v[152:155], v[176:179], v[244:247]
    v_permlane16_swap_b32 v187, v167
    v_mfma_f32_16x16x32_bf16 v[24:27], v[160:163], v[180:183], v[240:243]
    v_permlane16_swap_b32 v190, v170
    v_mfma_f32_16x16x32_bf16 v[44:47], v[156:159], v[180:183], v[244:247]
    v_permlane16_swap_b32 v191, v171
    v_mfma_f32_16x16x32_bf16 v[28:31], v[164:167], v[184:187], v[240:243]
    v_cvt_pk_bf16_f32 v96, v56, v57
    v_cvt_pk_bf16_f32 v97, v58, v59
    v_mfma_f32_16x16x32_bf16 v[48:51], v[160:163], v[184:187], v[244:247]
    v_cvt_pk_bf16_f32 v98, v60, v61
    v_cvt_pk_bf16_f32 v99, v62, v63
    v_mfma_f32_16x16x32_bf16 v[32:35], v[168:171], v[188:191], v[240:243]
    v_cvt_pk_bf16_f32 v100, v64, v65
    v_cvt_pk_bf16_f32 v101, v66, v67
    v_mfma_f32_16x16x32_bf16 v[52:55], v[164:167], v[188:191], v[244:247]
    v_cvt_pk_bf16_f32 v102, v68, v69
    v_cvt_pk_bf16_f32 v103, v70, v71
    v_cvt_pk_bf16_f32 v104, v72, v73
    v_cvt_pk_bf16_f32 v105, v74, v75
    v_mfma_f32_16x16x16_bf16 v[76:79], v[174:175], v[252:253], v[248:251]
    v_max3_f32 v216, v16, v17, v18
    v_max_f32 v216, v216, v19
    v_max_f32 v20, v20, v40
    v_mfma_f32_16x16x16_bf16 v[80:83], v[178:179], v[252:253], v[248:251]
    v_max_f32 v21, v21, v41
    v_max_f32 v22, v22, v42
    v_max_f32 v23, v23, v43
    v_mfma_f32_16x16x16_bf16 v[84:87], v[182:183], v[252:253], v[248:251]
    v_max3_f32 v217, v20, v21, v22
    v_max_f32 v217, v217, v23
    v_max_f32 v24, v24, v44
    v_mfma_f32_16x16x16_bf16 v[88:91], v[186:187], v[252:253], v[248:251]
    v_max_f32 v25, v25, v45
    v_max_f32 v26, v26, v46
    v_max_f32 v27, v27, v47
    v_mfma_f32_16x16x16_bf16 v[92:95], v[190:191], v[252:253], v[248:251]
    v_max3_f32 v218, v24, v25, v26
    v_max_f32 v218, v218, v27
    v_max_f32 v28, v28, v48
    v_max_f32 v29, v29, v49
    v_max_f32 v30, v30, v50
    v_max_f32 v31, v31, v51
    v_max3_f32 v219, v28, v29, v30
    v_max_f32 v219, v219, v31
    v_max_f32 v32, v32, v52
    v_max_f32 v33, v33, v53
    v_max_f32 v34, v34, v54
    v_max_f32 v35, v35, v55
    v_max3_f32 v220, v32, v33, v34
    v_max_f32 v220, v220, v35
    v_mov_b32 v231, v220
    v_permlane16_swap_b32 v216, v217
    v_permlane16_swap_b32 v218, v219
    v_permlane16_swap_b32 v220, v231
    v_max_f32 v216, v216, v217
    v_max_f32 v218, v218, v219
    v_max_f32 v220, v220, v231
    v_mov_b32 v231, v220
    v_permlane32_swap_b32 v216, v218
    v_cvt_pk_bf16_f32 v106, v76, v77
    v_permlane32_swap_b32 v220, v231
    v_max_f32 v216, v216, v218
    v_max_f32 v220, v220, v231
    v_mul_f32 v221, s16, v216
    v_mul_f32 v223, s16, v216
    v_mul_f32 v225, s16, v220
    v_cvt_pk_bf16_f32 v107, v78, v79
    v_permlane32_swap_b32 v221, v223
    v_mov_b32 v222, v221
    v_mov_b32 v224, v223
    v_cvt_pk_bf16_f32 v108, v80, v81
    v_cvt_pk_bf16_f32 v109, v82, v83
    v_permlane16_swap_b32 v221, v222
    v_permlane16_swap_b32 v223, v224
    v_pk_fma_f32 v[16:17], v[16:17], s[16:17], v[220:221] op_sel:[0,0,1] op_sel_hi:[1,0,1] neg_lo:[0,0,1] neg_hi:[0,0,1]
    v_pk_fma_f32 v[18:19], v[18:19], s[16:17], v[220:221] op_sel:[0,0,1] op_sel_hi:[1,0,1] neg_lo:[0,0,1] neg_hi:[0,0,1]
    v_exp_f32 v16, v16
    v_exp_f32 v17, v17
    v_exp_f32 v18, v18
    v_exp_f32 v19, v19
    v_cvt_pk_bf16_f32 v110, v84, v85
    v_cvt_pk_bf16_f32 v111, v86, v87
    v_cvt_pk_bf16_f32 v154, v16, v17
    v_cvt_pk_bf16_f32 v155, v18, v19
    s_nop 1
    v_mfma_f32_16x16x16_bf16 v[36:39], v[106:107], v[154:155], 0
    v_mfma_f32_16x16x16_bf16 v[56:59], v[96:97], v[154:155], 0
    v_pk_fma_f32 v[20:21], v[20:21], s[16:17], v[222:223] op_sel:[0,0,0] op_sel_hi:[1,0,0] neg_lo:[0,0,1] neg_hi:[0,0,1]
    v_pk_fma_f32 v[22:23], v[22:23], s[16:17], v[222:223] op_sel:[0,0,0] op_sel_hi:[1,0,0] neg_lo:[0,0,1] neg_hi:[0,0,1]
    v_exp_f32 v20, v20
    v_exp_f32 v21, v21
    v_exp_f32 v22, v22
    v_exp_f32 v23, v23
    s_nop 0
    v_rcp_f32 v226, v37
    v_cvt_pk_bf16_f32 v112, v88, v89
    v_cvt_pk_bf16_f32 v113, v90, v91
    v_cvt_pk_bf16_f32 v158, v20, v21
    v_cvt_pk_bf16_f32 v159, v22, v23
    v_and_b32 v156, v10, v158
    v_and_b32 v157, v11, v159
    v_and_b32 v158, v8, v158
    v_and_b32 v159, v9, v159
    v_pk_mul_f32 v[56:57], v[56:57], v[226:227] op_sel:[0,0] op_sel_hi:[1,0]
    v_pk_mul_f32 v[58:59], v[58:59], v[226:227] op_sel:[0,0] op_sel_hi:[1,0]
    v_mfma_f32_16x16x32_bf16 v[40:43], v[106:109], v[156:159], 0
    v_mul_f32 v128, v36, v226
    v_cvt_pk_bf16_f32 v116, v56, v57
    v_mfma_f32_16x16x32_bf16 v[60:63], v[96:99], v[156:159], 0
    v_cvt_pk_bf16_f32 v117, v58, v59
    v_pk_fma_f32 v[24:25], v[24:25], s[16:17], v[222:223] op_sel:[0,0,1] op_sel_hi:[1,0,1] neg_lo:[0,0,1] neg_hi:[0,0,1]
    v_pk_fma_f32 v[26:27], v[26:27], s[16:17], v[222:223] op_sel:[0,0,1] op_sel_hi:[1,0,1] neg_lo:[0,0,1] neg_hi:[0,0,1]
    v_exp_f32 v24, v24
    v_exp_f32 v25, v25
    v_exp_f32 v26, v26
    v_exp_f32 v27, v27
    v_rcp_f32 v227, v41
    v_cvt_pk_bf16_f32 v114, v92, v93
    v_cvt_pk_bf16_f32 v115, v94, v95
    v_cvt_pk_bf16_f32 v162, v24, v25
    v_cvt_pk_bf16_f32 v163, v26, v27
    v_and_b32 v160, v10, v162
    v_and_b32 v161, v11, v163
    v_and_b32 v162, v8, v162
    v_and_b32 v163, v9, v163
    v_pk_mul_f32 v[60:61], v[60:61], v[226:227] op_sel:[0,1] op_sel_hi:[1,1]
    v_pk_mul_f32 v[62:63], v[62:63], v[226:227] op_sel:[0,1] op_sel_hi:[1,1]
    v_mfma_f32_16x16x32_bf16 v[44:47], v[108:111], v[160:163], 0
    v_mul_f32 v129, v40, v227
    v_cvt_pk_bf16_f32 v118, v60, v61
    v_mfma_f32_16x16x32_bf16 v[64:67], v[98:101], v[160:163], 0
    v_cvt_pk_bf16_f32 v119, v62, v63
    v_permlane16_swap_b32 v116, v118
    s_nop 0
    v_permlane16_swap_b32 v117, v119
    buffer_store_dwordx4 v[116:119], v3, s[48:51], 0 offen offset:0 sc1
    v_pk_fma_f32 v[28:29], v[28:29], s[16:17], v[224:225] op_sel:[0,0,0] op_sel_hi:[1,0,0] neg_lo:[0,0,1] neg_hi:[0,0,1]
    v_pk_fma_f32 v[30:31], v[30:31], s[16:17], v[224:225] op_sel:[0,0,0] op_sel_hi:[1,0,0] neg_lo:[0,0,1] neg_hi:[0,0,1]
    v_exp_f32 v28, v28
    v_exp_f32 v29, v29
    v_exp_f32 v30, v30
    v_exp_f32 v31, v31
    v_rcp_f32 v228, v45
    v_cvt_pk_bf16_f32 v166, v28, v29
    v_cvt_pk_bf16_f32 v167, v30, v31
    v_and_b32 v164, v10, v166
    v_and_b32 v165, v11, v167
    v_and_b32 v166, v8, v166
    v_and_b32 v167, v9, v167
    v_pk_mul_f32 v[64:65], v[64:65], v[228:229] op_sel:[0,0] op_sel_hi:[1,0]
    v_pk_mul_f32 v[66:67], v[66:67], v[228:229] op_sel:[0,0] op_sel_hi:[1,0]
    v_mfma_f32_16x16x32_bf16 v[48:51], v[110:113], v[164:167], 0
    v_mul_f32 v130, v44, v228
    v_cvt_pk_bf16_f32 v120, v64, v65
    v_mfma_f32_16x16x32_bf16 v[68:71], v[100:103], v[164:167], 0
    v_cvt_pk_bf16_f32 v121, v66, v67
    v_pk_fma_f32 v[32:33], v[32:33], s[16:17], v[224:225] op_sel:[0,0,1] op_sel_hi:[1,0,1] neg_lo:[0,0,1] neg_hi:[0,0,1]
    v_pk_fma_f32 v[34:35], v[34:35], s[16:17], v[224:225] op_sel:[0,0,1] op_sel_hi:[1,0,1] neg_lo:[0,0,1] neg_hi:[0,0,1]
    v_exp_f32 v32, v32
    v_exp_f32 v33, v33
    v_exp_f32 v34, v34
    v_exp_f32 v35, v35
    v_rcp_f32 v229, v49
    v_cvt_pk_bf16_f32 v170, v32, v33
    v_cvt_pk_bf16_f32 v171, v34, v35
    v_and_b32 v168, v10, v170
    v_and_b32 v169, v11, v171
    v_and_b32 v170, v8, v170
    v_and_b32 v171, v9, v171
    v_pk_mul_f32 v[68:69], v[68:69], v[228:229] op_sel:[0,1] op_sel_hi:[1,1]
    v_pk_mul_f32 v[70:71], v[70:71], v[228:229] op_sel:[0,1] op_sel_hi:[1,1]
    v_mfma_f32_16x16x32_bf16 v[52:55], v[112:115], v[168:171], 0
    v_mul_f32 v131, v48, v229
    v_cvt_pk_bf16_f32 v122, v68, v69
    v_mfma_f32_16x16x32_bf16 v[72:75], v[102:105], v[168:171], 0
    v_cvt_pk_bf16_f32 v123, v70, v71
    v_permlane16_swap_b32 v120, v122
    s_nop 0
    v_permlane16_swap_b32 v121, v123
    buffer_store_dwordx4 v[120:123], v4, s[48:51], 0 offen offset:512 sc1
    v_permlane16_swap_b32 v128, v129
    v_permlane16_swap_b32 v130, v131
    v_rcp_f32 v230, v53
    v_cvt_pk_bf16_f32 v134, v128, v129
    v_cvt_pk_bf16_f32 v135, v130, v131
    v_mul_f32 v132, v52, v230
    v_pk_mul_f32 v[72:73], v[72:73], v[230:231] op_sel:[0,0] op_sel_hi:[1,0]
    v_permlane32_swap_b32 v134, v135
    buffer_store_dwordx2 v[134:135], v12, s[48:51], 0 offen sc1
    v_permlane16_swap_b32 v132, v231
    v_pk_mul_f32 v[74:75], v[74:75], v[230:231] op_sel:[0,0] op_sel_hi:[1,0]
    v_cvt_pk_bf16_f32 v192, v132, v231
    v_cvt_pk_bf16_f32 v124, v72, v73
    v_cvt_pk_bf16_f32 v125, v74, v75
    v_permlane32_swap_b32 v192, v193
    buffer_store_dwordx2 v[192:193], v13, s[48:51], 0 offen offset:512 sc1
    v_permlane16_swap_b32 v124, v126
    v_permlane16_swap_b32 v125, v127
    buffer_store_dwordx4 v[124:127], v7, s[48:51], 0 offen offset:1024 sc1
    v_lshlrev_b32 v19, 2, v15
    v_sub_u32 v19, v14, v19
    v_add_u32 v19, s10, v19
    v_mov_b32 v4, v254
    buffer_load_dwordx2 v[64:65], v14, s[40:43], 0 offen offset:0
    buffer_load_dwordx2 v[68:69], v14, s[40:43], 0 offen offset:2560
    buffer_load_dwordx2 v[72:73], v14, s[40:43], s11 offen offset:0
    buffer_load_dwordx2 v[76:77], v14, s[40:43], s11 offen offset:2560
    buffer_load_dword v66, v19, s[40:43], 0 offen offset:0
    buffer_load_dword v70, v19, s[40:43], 0 offen offset:2560
    buffer_load_dword v74, v19, s[40:43], s11 offen offset:0
    buffer_load_dword v78, v19, s[40:43], s11 offen offset:2560
    buffer_load_dwordx4 v[80:83], v4, s[48:51], 0 offen offset:0 sc1
    buffer_load_dwordx4 v[84:87], v4, s[48:51], 0 offen offset:16 sc1
    ds_add_u32 v232, v233 offset:24
    s_lshr_b32 s6, s18, 6
    s_add_u32 s7, s17, 79
    s_min_u32 s7, s7, 1023
    s_lshr_b32 s7, s7, 6
    s_sub_u32 s7, s7, s6
    s_mul_i32 s7, s7, 7
    s_add_u32 s7, s7, 7
    s_bfm_b64 s[12:13], s7, 0
    v_mul_u32_u24 v10, 37, v0
    v_lshrrev_b32 v10, 8, v10
    v_add_u32 v10, s6, v10
    v_lshlrev_b32 v10, 6, v10
    v_max_u32 v10, 7, v10
    v_subrev_u32 v10, 7, v10
    v_mul_u32_u24 v10, 898, v10
    v_lshrrev_b32 v10, 16, v10
    v_sub_u32 v10, s34, v10
    s_lshl_b32 s8, s33, 4
    s_add_u32 s6, s6, s8
    s_mul_i32 s6, s6, 3584
    s_lshl_b32 s8, s32, 2
    s_add_u32 s6, s6, s8
    s_add_u32 s6, s6, 6422528
    v_lshl_add_u32 v10, v10, 5, s6
    v_lshl_add_u32 v6, v0, 9, v10
    v_add_u32 v1, 2048, v5
    v_add_u32 v2, 63488, v5
    s_mul_i32 s22, s19, 33280
    s_lshl_b32 s6, s26, 4
    s_add_u32 s22, s22, s6
    s_add_u32 s22, s22, 262144
    s_mul_i32 s23, s19, 8320
    s_lshl_b32 s6, s26, 3
    s_add_u32 s23, s23, s6
    s_add_u32 s23, s23, 2392064
    v_lshrrev_b32 v7, 4, v0
    v_mul_u32_u24 v7, 16640, v7
    v_lshl_add_u32 v5, v15, 4, v7
    v_lshl_add_u32 v7, v15, 3, v7
    v_mov_b32 v16, 0
    v_mov_b32 v17, 1
    v_mov_b32 v18, s35
L_w1:
    ds_read_b32 v11, v16 offset:8
    s_waitcnt lgkmcnt(0)
    v_and_b32 v11, 0x3000, v11
    v_cmp_ne_u32 vcc, 0x3000, v11
    s_nop 0
    s_cbranch_vccnz L_w1
    ds_read_b32 v3, v16 offset:16
    ds_read_b128 v[144:147], v1 offset:0
    ds_read_b128 v[148:151], v1 offset:1024
    ds_read_b128 v[152:155], v1 offset:2048
    ds_read_b128 v[156:159], v1 offset:3072
    ds_read_b128 v[160:163], v1 offset:4096
    ds_read_b128 v[164:167], v1 offset:5120
    ds_read_b128 v[168:171], v1 offset:6144
    ds_read_b128 v[172:175], v1 offset:7168
    ds_read_b128 v[176:179], v1 offset:8192
    ds_read_b128 v[180:183], v1 offset:9216
    ds_read_b128 v[184:187], v1 offset:10240
    ds_read_b128 v[188:191], v1 offset:11264
    s_mov_b64 exec, 1
    s_waitcnt vmcnt(10)
    ds_add_rtn_u32 v17, v16, v17
    s_waitcnt lgkmcnt(0)
    v_readfirstlane_b32 s6, v17
    s_nop 0
    s_cmp_lg_u32 s6, 3
    s_cbranch_scc1 L_nf_22
    s_mov_b64 exec, s[12:13]
    buffer_atomic_swap v18, v6, s[48:51], 0 offen sc1
    s_waitcnt vmcnt(1)
    s_branch L_nf_22_b
L_nf_22:
    s_waitcnt vmcnt(0)
L_nf_22_b:
    s_mov_b64 exec, -1
L_gl_20:
    v_xor_b32 v20, s35, v81
    v_xor_b32 v21, s35, v83
    v_xor_b32 v22, s35, v85
    v_or3_b32 v20, v20, v21, v22
    v_xor_b32 v21, s35, v87
    v_or_b32 v20, v20, v21
    v_cmp_ne_u32 vcc, 0, v20
    s_nop 0
    s_cbranch_vccz L_gok_21
    buffer_load_dwordx4 v[80:83], v4, s[48:51], 0 offen sc1
    buffer_load_dwordx4 v[84:87], v4, s[48:51], 0 offen offset:16 sc1
    s_waitcnt vmcnt(0)
    s_sub_u32 s3, s3, 1
    s_cmp_gt_i32 s3, 0
    s_cbranch_scc1 L_gl_20
L_gok_21:
    ds_read_b128 v[192:195], v1 offset:12288
    v_mov_b32 v8, v80
    v_sub_f32 v20, 1.0, v80
    v_lshlrev_b32 v40, 16, v64
    ds_read_b128 v[196:199], v1 offset:13312
    v_and_b32 v44, 0xffff0000, v64
    v_mul_f32 v40, v20, v40
    v_mul_f32 v44, v20, v44
    ds_read_b128 v[200:203], v1 offset:14336
    v_lshlrev_b32 v48, 16, v65
    v_and_b32 v52, 0xffff0000, v65
    v_mul_f32 v48, v20, v48
    ds_read_b128 v[204:207], v1 offset:15360
    v_mul_f32 v52, v20, v52
    v_lshlrev_b32 v56, 16, v66
    v_and_b32 v60, 0xffff0000, v66
    ds_read_b128 v[208:211], v1 offset:16384
    v_mul_f32 v56, v20, v56
    v_mul_f32 v60, v20, v60
    v_mov_b32 v9, v82
    ds_read_b128 v[212:215], v1 offset:17408
    v_sub_f32 v20, 1.0, v82
    v_lshlrev_b32 v41, 16, v68
    v_and_b32 v45, 0xffff0000, v68
    ds_read_b128 v[216:219], v1 offset:18432
    v_mul_f32 v41, v20, v41
    v_mul_f32 v45, v20, v45
    v_lshlrev_b32 v49, 16, v69
    ds_read_b128 v[220:223], v1 offset:19456
    v_and_b32 v53, 0xffff0000, v69
    v_mul_f32 v49, v20, v49
    v_mul_f32 v53, v20, v53
    ds_read_b128 v[224:227], v1 offset:20480
    v_lshlrev_b32 v57, 16, v70
    v_and_b32 v61, 0xffff0000, v70
    v_mul_f32 v57, v20, v57
    ds_read_b128 v[228:231], v1 offset:21504
    v_mul_f32 v61, v20, v61
    v_mov_b32 v12, v84
    v_sub_f32 v20, 1.0, v84
    ds_read_b128 v[232:235], v1 offset:22528
    v_lshlrev_b32 v42, 16, v72
    v_and_b32 v46, 0xffff0000, v72
    v_mul_f32 v42, v20, v42
    ds_read_b128 v[236:239], v1 offset:23552
    v_mul_f32 v46, v20, v46
    v_lshlrev_b32 v50, 16, v73
    v_and_b32 v54, 0xffff0000, v73
    ds_read_b128 v[240:243], v1 offset:24576
    v_mul_f32 v50, v20, v50
    v_mul_f32 v54, v20, v54
    v_lshlrev_b32 v58, 16, v74
    ds_read_b128 v[244:247], v1 offset:25600
    v_and_b32 v62, 0xffff0000, v74
    v_mul_f32 v58, v20, v58
    v_mul_f32 v62, v20, v62
    ds_read_b128 v[248:251], v1 offset:26624
    v_mov_b32 v13, v86
    v_sub_f32 v20, 1.0, v86
    v_lshlrev_b32 v43, 16, v76
    ds_read_b128 v[252:255], v1 offset:27648
    v_and_b32 v47, 0xffff0000, v76
    v_mul_f32 v43, v20, v43
    v_mul_f32 v47, v20, v47
    v_lshlrev_b32 v51, 16, v77
    v_and_b32 v55, 0xffff0000, v77
    v_mul_f32 v51, v20, v51
    v_mul_f32 v55, v20, v55
    v_lshlrev_b32 v59, 16, v78
    v_and_b32 v63, 0xffff0000, v78
    v_mul_f32 v59, v20, v59
    v_mul_f32 v63, v20, v63
    s_waitcnt lgkmcnt(0)
    s_barrier
    buffer_load_dwordx4 v[64:67], v5, s[48:51], s22 offen sc1
    s_add_u32 s22, s22, 66560
    buffer_load_dwordx4 v[68:71], v5, s[48:51], s22 offen sc1
    s_add_u32 s22, s22, 66560
    buffer_load_dwordx4 v[72:75], v5, s[48:51], s22 offen sc1
    s_add_u32 s22, s22, 66560
    buffer_load_dwordx4 v[76:79], v5, s[48:51], s22 offen sc1
    s_add_u32 s22, s22, 66560
    buffer_load_dwordx4 v[80:83], v5, s[48:51], s22 offen sc1
    s_add_u32 s22, s22, 66560
    buffer_load_dwordx4 v[84:87], v5, s[48:51], s22 offen sc1
    s_add_u32 s22, s22, 66560
    v_readfirstlane_b32 s14, v3
    v_lshrrev_b32 v6, 2, v0
    v_and_b32 v6, 12, v6
    s_lshl_b32 s7, s28, 4
    s_sub_u32 s7, s14, s7
    v_sub_u32 v6, s7, v6
    v_mov_b32 v3, s25
    v_mov_b32 v0, v19
    s_waitcnt vmcnt(5)
    v_mfma_f32_16x16x32_bf16 v[16:19], v[64:67], v[144:147], 0
    buffer_load_dwordx4 v[88:91], v5, s[48:51], s22 offen sc1
    v_mfma_f32_16x16x32_bf16 v[20:23], v[64:67], v[148:151], 0
    s_add_u32 s22, s22, 66560
    ds_read_b128 v[144:147], v1 offset:28672
    v_mfma_f32_16x16x32_bf16 v[24:27], v[64:67], v[152:155], 0
    buffer_load_dwordx4 v[92:95], v5, s[48:51], s22 offen sc1
    v_mfma_f32_16x16x32_bf16 v[28:31], v[64:67], v[156:159], 0
    s_add_u32 s22, s22, 66560
    ds_read_b128 v[148:151], v1 offset:29696
    v_mfma_f32_16x16x32_bf16 v[32:35], v[64:67], v[160:163], 0
    ds_read_b128 v[152:155], v1 offset:30720
    v_mfma_f32_16x16x32_bf16 v[36:39], v[64:67], v[164:167], 0
    ds_read_b128 v[156:159], v1 offset:31744
    s_waitcnt vmcnt(6)
    v_mfma_f32_16x16x32_bf16 v[16:19], v[68:71], v[168:171], v[16:19]
    buffer_load_dwordx4 v[96:99], v5, s[48:51], s22 offen sc1
    v_mfma_f32_16x16x32_bf16 v[20:23], v[68:71], v[172:175], v[20:23]
    s_add_u32 s22, s22, 66560
    ds_read_b128 v[160:163], v1 offset:32768
    v_mfma_f32_16x16x32_bf16 v[24:27], v[68:71], v[176:179], v[24:27]
    buffer_load_dwordx4 v[100:103], v5, s[48:51], s22 offen sc1
    v_mfma_f32_16x16x32_bf16 v[28:31], v[68:71], v[180:183], v[28:31]
    s_add_u32 s22, s22, 66560
    ds_read_b128 v[164:167], v1 offset:33792
    v_mfma_f32_16x16x32_bf16 v[32:35], v[68:71], v[184:187], v[32:35]
    ds_read_b128 v[168:171], v1 offset:34816
    v_mfma_f32_16x16x32_bf16 v[36:39], v[68:71], v[188:191], v[36:39]
    ds_read_b128 v[172:175], v1 offset:35840
    s_waitcnt vmcnt(7)
    v_mfma_f32_16x16x32_bf16 v[16:19], v[72:75], v[192:195], v[16:19]
    buffer_load_dwordx4 v[104:107], v5, s[48:51], s22 offen sc1
    v_mfma_f32_16x16x32_bf16 v[20:23], v[72:75], v[196:199], v[20:23]
    s_add_u32 s22, s22, 66560
    ds_read_b128 v[176:179], v1 offset:36864
    v_mfma_f32_16x16x32_bf16 v[24:27], v[72:75], v[200:203], v[24:27]
    ds_read_b128 v[180:183], v1 offset:37888
    v_mfma_f32_16x16x32_bf16 v[28:31], v[72:75], v[204:207], v[28:31]
    ds_read_b128 v[184:187], v1 offset:38912
    v_mfma_f32_16x16x32_bf16 v[32:35], v[72:75], v[208:211], v[32:35]
    ds_read_b128 v[188:191], v1 offset:39936
    v_mfma_f32_16x16x32_bf16 v[36:39], v[72:75], v[212:215], v[36:39]
    ds_read_b128 v[192:195], v1 offset:40960
L_touch2:
    s_cbranch_execz L_touched
    s_waitcnt vmcnt(7)
    v_mfma_f32_16x16x32_bf16 v[16:19], v[76:79], v[216:219], v[16:19]
    buffer_load_dwordx4 v[108:111], v5, s[48:51], s22 offen sc1
    v_mfma_f32_16x16x32_bf16 v[20:23], v[76:79], v[220:223], v[20:23]
    s_add_u32 s22, s22, 66560
    ds_read_b128 v[196:199], v1 offset:41984
    v_mfma_f32_16x16x32_bf16 v[24:27], v[76:79], v[224:227], v[24:27]
    ds_read_b128 v[200:203], v1 offset:43008
    v_mfma_f32_16x16x32_bf16 v[28:31], v[76:79], v[228:231], v[28:31]
    ds_read_b128 v[204:207], v1 offset:44032
    v_mfma_f32_16x16x32_bf16 v[32:35], v[76:79], v[232:235], v[32:35]
    ds_read_b128 v[208:211], v1 offset:45056
    v_mfma_f32_16x16x32_bf16 v[36:39], v[76:79], v[236:239], v[36:39]
    ds_read_b128 v[212:215], v1 offset:46080
    s_waitcnt vmcnt(7) lgkmcnt(15)
    v_mfma_f32_16x16x32_bf16 v[16:19], v[80:83], v[240:243], v[16:19]
    buffer_load_dwordx4 v[112:115], v5, s[48:51], s22 offen sc1
    v_mfma_f32_16x16x32_bf16 v[20:23], v[80:83], v[244:247], v[20:23]
    s_add_u32 s22, s22, 66560
    ds_read_b128 v[216:219], v1 offset:47104
    v_mfma_f32_16x16x32_bf16 v[24:27], v[80:83], v[248:251], v[24:27]
    ds_read_b128 v[220:223], v1 offset:48128
    v_mfma_f32_16x16x32_bf16 v[28:31], v[80:83], v[252:255], v[28:31]
    ds_read_b128 v[224:227], v1 offset:49152
    v_mfma_f32_16x16x32_bf16 v[32:35], v[80:83], v[144:147], v[32:35]
    ds_read_b128 v[228:231], v1 offset:50176
    v_mfma_f32_16x16x32_bf16 v[36:39], v[80:83], v[148:151], v[36:39]
    ds_read_b128 v[232:235], v1 offset:51200
    s_waitcnt vmcnt(7) lgkmcnt(15)
    v_mfma_f32_16x16x32_bf16 v[16:19], v[84:87], v[152:155], v[16:19]
    buffer_load_dwordx4 v[116:119], v5, s[48:51], s22 offen sc1
    v_mfma_f32_16x16x32_bf16 v[20:23], v[84:87], v[156:159], v[20:23]
    s_add_u32 s22, s22, 66560
    ds_read_b128 v[236:239], v1 offset:52224
    v_mfma_f32_16x16x32_bf16 v[24:27], v[84:87], v[160:163], v[24:27]
    ds_read_b128 v[240:243], v1 offset:53248
    v_mfma_f32_16x16x32_bf16 v[28:31], v[84:87], v[164:167], v[28:31]
    ds_read_b128 v[244:247], v1 offset:54272
    v_mfma_f32_16x16x32_bf16 v[32:35], v[84:87], v[168:171], v[32:35]
    ds_read_b128 v[248:251], v1 offset:55296
    v_mfma_f32_16x16x32_bf16 v[36:39], v[84:87], v[172:175], v[36:39]
    ds_read_b128 v[252:255], v1 offset:56320
    s_waitcnt vmcnt(7) lgkmcnt(14)
    v_mfma_f32_16x16x32_bf16 v[16:19], v[88:91], v[176:179], v[16:19]
    buffer_load_dwordx4 v[120:123], v5, s[48:51], s22 offen sc1
    ds_read_b128 v[144:147], v1 offset:57344
    v_mfma_f32_16x16x32_bf16 v[20:23], v[88:91], v[180:183], v[20:23]
    s_add_u32 s22, s22, 66560
    ds_read_b128 v[148:151], v1 offset:58368
    v_mfma_f32_16x16x32_bf16 v[24:27], v[88:91], v[184:187], v[24:27]
    ds_read_b128 v[152:155], v1 offset:59392
    v_mfma_f32_16x16x32_bf16 v[28:31], v[88:91], v[188:191], v[28:31]
    ds_read_b128 v[156:159], v1 offset:60416
    v_mfma_f32_16x16x32_bf16 v[32:35], v[88:91], v[192:195], v[32:35]
    ds_read_b128 v[160:163], v2 offset:0
    v_mfma_f32_16x16x32_bf16 v[36:39], v[88:91], v[196:199], v[36:39]
    ds_read_b128 v[164:167], v2 offset:1024
    s_waitcnt vmcnt(7) lgkmcnt(14)
    v_mfma_f32_16x16x32_bf16 v[16:19], v[92:95], v[200:203], v[16:19]
    buffer_load_dwordx4 v[124:127], v5, s[48:51], s22 offen sc1
    ds_read_b128 v[168:171], v2 offset:2048
    v_mfma_f32_16x16x32_bf16 v[20:23], v[92:95], v[204:207], v[20:23]
    s_add_u32 s22, s22, 66560
    ds_read_b128 v[172:175], v2 offset:3072
    v_mfma_f32_16x16x32_bf16 v[24:27], v[92:95], v[208:211], v[24:27]
    ds_read_b128 v[176:179], v2 offset:4096
    v_mfma_f32_16x16x32_bf16 v[28:31], v[92:95], v[212:215], v[28:31]
    ds_read_b128 v[180:183], v2 offset:5120
    v_mfma_f32_16x16x32_bf16 v[32:35], v[92:95], v[216:219], v[32:35]
    ds_read_b128 v[184:187], v2 offset:6144
    v_mfma_f32_16x16x32_bf16 v[36:39], v[92:95], v[220:223], v[36:39]
    ds_read_b128 v[188:191], v2 offset:7168
    s_waitcnt vmcnt(7) lgkmcnt(14)
    v_mfma_f32_16x16x32_bf16 v[16:19], v[96:99], v[224:227], v[16:19]
    buffer_load_dwordx2 v[128:129], v7, s[48:51], s23 offen sc1
    ds_read_b128 v[192:195], v2 offset:8192
    v_mfma_f32_16x16x32_bf16 v[20:23], v[96:99], v[228:231], v[20:23]
    s_add_u32 s23, s23, 8320
    ds_read_b128 v[196:199], v2 offset:9216
    v_mfma_f32_16x16x32_bf16 v[24:27], v[96:99], v[232:235], v[24:27]
    buffer_load_dwordx2 v[130:131], v7, s[48:51], s23 offen sc1
    ds_read_b128 v[200:203], v2 offset:10240
    v_mfma_f32_16x16x32_bf16 v[28:31], v[96:99], v[236:239], v[28:31]
    s_add_u32 s23, s23, 58240
    ds_read_b128 v[204:207], v2 offset:11264
    v_mfma_f32_16x16x32_bf16 v[32:35], v[96:99], v[240:243], v[32:35]
    ds_read_b128 v[208:211], v2 offset:12288
    v_mfma_f32_16x16x32_bf16 v[36:39], v[96:99], v[244:247], v[36:39]
    ds_read_b128 v[212:215], v2 offset:13312
    s_waitcnt vmcnt(8) lgkmcnt(14)
    v_mfma_f32_16x16x32_bf16 v[16:19], v[100:103], v[248:251], v[16:19]
    buffer_load_dwordx2 v[132:133], v7, s[48:51], s23 offen sc1
    ds_read_b128 v[216:219], v2 offset:14336
    v_mfma_f32_16x16x32_bf16 v[20:23], v[100:103], v[252:255], v[20:23]
    s_add_u32 s23, s23, 8320
    ds_read_b128 v[220:223], v2 offset:15360
    v_mfma_f32_16x16x32_bf16 v[24:27], v[100:103], v[144:147], v[24:27]
    buffer_load_dwordx2 v[134:135], v7, s[48:51], s23 offen sc1
    ds_read_b128 v[224:227], v2 offset:16384
    v_mfma_f32_16x16x32_bf16 v[28:31], v[100:103], v[148:151], v[28:31]
    s_add_u32 s23, s23, 58240
    ds_read_b128 v[228:231], v2 offset:17408
    v_mfma_f32_16x16x32_bf16 v[32:35], v[100:103], v[152:155], v[32:35]
    ds_read_b128 v[232:235], v2 offset:18432
    v_mfma_f32_16x16x32_bf16 v[36:39], v[100:103], v[156:159], v[36:39]
    ds_read_b128 v[236:239], v2 offset:19456
    s_waitcnt vmcnt(9) lgkmcnt(14)
    v_mfma_f32_16x16x32_bf16 v[16:19], v[104:107], v[160:163], v[16:19]
    buffer_load_dwordx2 v[136:137], v7, s[48:51], s23 offen sc1
    ds_read_b128 v[240:243], v2 offset:20480
    v_mfma_f32_16x16x32_bf16 v[20:23], v[104:107], v[164:167], v[20:23]
    s_add_u32 s23, s23, 8320
    ds_read_b128 v[244:247], v2 offset:21504
    v_mfma_f32_16x16x32_bf16 v[24:27], v[104:107], v[168:171], v[24:27]
    buffer_load_dwordx2 v[138:139], v7, s[48:51], s23 offen sc1
    ds_read_b128 v[248:251], v2 offset:22528
    v_mfma_f32_16x16x32_bf16 v[28:31], v[104:107], v[172:175], v[28:31]
    s_add_u32 s23, s23, 58240
    ds_read_b128 v[252:255], v2 offset:23552
    v_mfma_f32_16x16x32_bf16 v[32:35], v[104:107], v[176:179], v[32:35]
    ds_read_b128 v[144:147], v2 offset:24576
    v_mfma_f32_16x16x32_bf16 v[36:39], v[104:107], v[180:183], v[36:39]
    ds_read_b128 v[148:151], v2 offset:25600
    s_waitcnt vmcnt(10) lgkmcnt(14)
    v_mfma_f32_16x16x32_bf16 v[16:19], v[108:111], v[184:187], v[16:19]
    buffer_load_dwordx2 v[140:141], v7, s[48:51], s23 offen sc1
    ds_read_b128 v[152:155], v2 offset:26624
    v_mfma_f32_16x16x32_bf16 v[20:23], v[108:111], v[188:191], v[20:23]
    s_add_u32 s23, s23, 8320
    ds_read_b128 v[156:159], v2 offset:27648
    v_mfma_f32_16x16x32_bf16 v[24:27], v[108:111], v[192:195], v[24:27]
    buffer_load_dwordx2 v[142:143], v7, s[48:51], s23 offen sc1
    ds_read_b128 v[160:163], v2 offset:28672
    v_mfma_f32_16x16x32_bf16 v[28:31], v[108:111], v[196:199], v[28:31]
    s_add_u32 s23, s23, 58240
    ds_read_b128 v[164:167], v2 offset:29696
    v_mfma_f32_16x16x32_bf16 v[32:35], v[108:111], v[200:203], v[32:35]
    ds_read_b128 v[168:171], v2 offset:30720
    v_mfma_f32_16x16x32_bf16 v[36:39], v[108:111], v[204:207], v[36:39]
    ds_read_b128 v[172:175], v2 offset:31744
    s_waitcnt vmcnt(11) lgkmcnt(15)
    v_mfma_f32_16x16x32_bf16 v[16:19], v[112:115], v[208:211], v[16:19]
    ds_read_b128 v[176:179], v2 offset:32768
    v_mfma_f32_16x16x32_bf16 v[20:23], v[112:115], v[212:215], v[20:23]
    ds_read_b128 v[180:183], v2 offset:33792
    v_mfma_f32_16x16x32_bf16 v[24:27], v[112:115], v[216:219], v[24:27]
    ds_read_b128 v[184:187], v2 offset:34816
    v_mfma_f32_16x16x32_bf16 v[28:31], v[112:115], v[220:223], v[28:31]
    ds_read_b128 v[188:191], v2 offset:35840
    s_waitcnt vmcnt(10) lgkmcnt(15)
    v_mfma_f32_16x16x32_bf16 v[16:19], v[116:119], v[224:227], v[16:19]
    ds_read_b128 v[192:195], v2 offset:36864
    v_mfma_f32_16x16x32_bf16 v[20:23], v[116:119], v[228:231], v[20:23]
    ds_read_b128 v[196:199], v2 offset:37888
    v_mfma_f32_16x16x32_bf16 v[24:27], v[116:119], v[232:235], v[24:27]
    ds_read_b128 v[200:203], v2 offset:38912
    v_mfma_f32_16x16x32_bf16 v[28:31], v[116:119], v[236:239], v[28:31]
    ds_read_b128 v[204:207], v2 offset:39936
    s_waitcnt vmcnt(9) lgkmcnt(15)
    v_mfma_f32_16x16x32_bf16 v[16:19], v[120:123], v[240:243], v[16:19]
    ds_read_b128 v[208:211], v2 offset:40960
    v_mfma_f32_16x16x32_bf16 v[20:23], v[120:123], v[244:247], v[20:23]
    ds_read_b128 v[212:215], v2 offset:41984
    v_mfma_f32_16x16x32_bf16 v[24:27], v[120:123], v[248:251], v[24:27]
    ds_read_b128 v[216:219], v2 offset:43008
    v_mfma_f32_16x16x32_bf16 v[28:31], v[120:123], v[252:255], v[28:31]
    ds_read_b128 v[220:223], v2 offset:44032
    s_waitcnt vmcnt(8) lgkmcnt(15)
    v_mfma_f32_16x16x32_bf16 v[16:19], v[124:127], v[144:147], v[16:19]
    ds_read_b128 v[224:227], v2 offset:45056
    v_mfma_f32_16x16x32_bf16 v[20:23], v[124:127], v[148:151], v[20:23]
    ds_read_b128 v[228:231], v2 offset:46080
    v_mfma_f32_16x16x32_bf16 v[24:27], v[124:127], v[152:155], v[24:27]
    ds_read_b128 v[232:235], v2 offset:47104
    v_mfma_f32_16x16x32_bf16 v[28:31], v[124:127], v[156:159], v[28:31]
    ds_read_b128 v[236:239], v2 offset:48128
    s_waitcnt vmcnt(6) lgkmcnt(15)
    v_mfma_f32_16x16x32_bf16 v[16:19], v[128:131], v[160:163], v[16:19]
    ds_read_b128 v[240:243], v2 offset:49152
    v_mfma_f32_16x16x32_bf16 v[20:23], v[128:131], v[164:167], v[20:23]
    ds_read_b128 v[244:247], v2 offset:50176
    v_mfma_f32_16x16x32_bf16 v[24:27], v[128:131], v[168:171], v[24:27]
    ds_read_b128 v[248:251], v2 offset:51200
    v_cmp_eq_u32 vcc, 0, v6
    v_mfma_f32_16x16x32_bf16 v[28:31], v[128:131], v[172:175], v[28:31]
    ds_read_b128 v[252:255], v2 offset:52224
    v_cndmask_b32 v64, v14, v3, vcc
    s_waitcnt vmcnt(4) lgkmcnt(15)
    v_mfma_f32_16x16x32_bf16 v[16:19], v[132:135], v[176:179], v[16:19]
    ds_read_b128 v[144:147], v2 offset:53248
    v_cndmask_b32 v68, v0, v3, vcc
    v_mfma_f32_16x16x32_bf16 v[20:23], v[132:135], v[180:183], v[20:23]
    ds_read_b128 v[148:151], v2 offset:54272
    v_cmp_eq_u32 vcc, 1, v6
    v_mfma_f32_16x16x32_bf16 v[24:27], v[132:135], v[184:187], v[24:27]
    ds_read_b128 v[152:155], v2 offset:55296
    v_cndmask_b32 v65, v14, v3, vcc
    v_mfma_f32_16x16x32_bf16 v[28:31], v[132:135], v[188:191], v[28:31]
    ds_read_b128 v[156:159], v2 offset:56320
    v_cndmask_b32 v69, v0, v3, vcc
    s_waitcnt vmcnt(2) lgkmcnt(15)
    v_mfma_f32_16x16x32_bf16 v[16:19], v[136:139], v[192:195], v[16:19]
    ds_read_b128 v[160:163], v2 offset:57344
    v_cmp_eq_u32 vcc, 2, v6
    v_mfma_f32_16x16x32_bf16 v[20:23], v[136:139], v[196:199], v[20:23]
    ds_read_b128 v[164:167], v2 offset:58368
    v_cndmask_b32 v66, v14, v3, vcc
    v_mfma_f32_16x16x32_bf16 v[24:27], v[136:139], v[200:203], v[24:27]
    ds_read_b128 v[168:171], v2 offset:59392
    v_cndmask_b32 v70, v0, v3, vcc
    v_mfma_f32_16x16x32_bf16 v[28:31], v[136:139], v[204:207], v[28:31]
    ds_read_b128 v[172:175], v2 offset:60416
    v_cmp_eq_u32 vcc, 3, v6
    s_waitcnt vmcnt(0) lgkmcnt(15)
    v_mfma_f32_16x16x32_bf16 v[16:19], v[140:143], v[208:211], v[16:19]
    v_cndmask_b32 v67, v14, v3, vcc
    v_mfma_f32_16x16x32_bf16 v[20:23], v[140:143], v[212:215], v[20:23]
    v_cndmask_b32 v71, v0, v3, vcc
    v_mfma_f32_16x16x32_bf16 v[24:27], v[140:143], v[216:219], v[24:27]
    v_mfma_f32_16x16x32_bf16 v[28:31], v[140:143], v[220:223], v[28:31]
    s_waitcnt lgkmcnt(12)
    s_cmp_eq_u32 s37, 6
    s_cbranch_scc1 L_cb6
    v_mfma_f32_16x16x32_bf16 v[32:35], v[112:115], v[224:227], v[32:35]
    v_mfma_f32_16x16x32_bf16 v[36:39], v[112:115], v[228:231], v[36:39]
    v_pk_fma_f32 v[16:17], v[16:17], v[8:9], v[40:41]
    v_pk_fma_f32 v[18:19], v[18:19], v[12:13], v[42:43]
    v_mfma_f32_16x16x32_bf16 v[32:35], v[116:119], v[232:235], v[32:35]
    v_pk_fma_f32 v[20:21], v[20:21], v[8:9], v[44:45]
    v_pk_fma_f32 v[22:23], v[22:23], v[12:13], v[46:47]
    v_mfma_f32_16x16x32_bf16 v[36:39], v[116:119], v[236:239], v[36:39]
    v_pk_fma_f32 v[24:25], v[24:25], v[8:9], v[48:49]
    v_pk_fma_f32 v[26:27], v[26:27], v[12:13], v[50:51]
    s_waitcnt lgkmcnt(8)
    v_mfma_f32_16x16x32_bf16 v[32:35], v[120:123], v[240:243], v[32:35]
    v_pk_fma_f32 v[28:29], v[28:29], v[8:9], v[52:53]
    v_pk_fma_f32 v[30:31], v[30:31], v[12:13], v[54:55]
    v_mfma_f32_16x16x32_bf16 v[36:39], v[120:123], v[244:247], v[36:39]
    v_cvt_pk_bf16_f32 v40, v16, v20
    v_cvt_pk_bf16_f32 v41, v24, v28
    v_mfma_f32_16x16x32_bf16 v[32:35], v[124:127], v[248:251], v[32:35]
    buffer_store_dwordx2 v[40:41], v64, s[52:55], 0 offen offset:0 sc1
    v_mfma_f32_16x16x32_bf16 v[36:39], v[124:127], v[252:255], v[36:39]
    v_cvt_pk_bf16_f32 v42, v17, v21
    v_cvt_pk_bf16_f32 v43, v25, v29
    s_waitcnt lgkmcnt(4)
    v_mfma_f32_16x16x32_bf16 v[32:35], v[128:131], v[144:147], v[32:35]
    buffer_store_dwordx2 v[42:43], v65, s[52:55], 0 offen offset:2560 sc1
    v_mfma_f32_16x16x32_bf16 v[36:39], v[128:131], v[148:151], v[36:39]
    v_cvt_pk_bf16_f32 v44, v18, v22
    v_cvt_pk_bf16_f32 v45, v26, v30
    v_mfma_f32_16x16x32_bf16 v[32:35], v[132:135], v[152:155], v[32:35]
    buffer_store_dwordx2 v[44:45], v66, s[52:55], s11 offen offset:0 sc1
    v_mfma_f32_16x16x32_bf16 v[36:39], v[132:135], v[156:159], v[36:39]
    v_cvt_pk_bf16_f32 v46, v19, v23
    v_cvt_pk_bf16_f32 v47, v27, v31
    s_waitcnt lgkmcnt(0)
    v_mfma_f32_16x16x32_bf16 v[32:35], v[136:139], v[160:163], v[32:35]
    buffer_store_dwordx2 v[46:47], v67, s[52:55], s11 offen offset:2560 sc1
    v_mfma_f32_16x16x32_bf16 v[36:39], v[136:139], v[164:167], v[36:39]
    v_mfma_f32_16x16x32_bf16 v[32:35], v[140:143], v[168:171], v[32:35]
    v_mfma_f32_16x16x32_bf16 v[36:39], v[140:143], v[172:175], v[36:39]
    s_nop 6
    v_pk_fma_f32 v[32:33], v[32:33], v[8:9], v[56:57]
    v_pk_fma_f32 v[34:35], v[34:35], v[12:13], v[58:59]
    v_pk_fma_f32 v[36:37], v[36:37], v[8:9], v[60:61]
    v_pk_fma_f32 v[38:39], v[38:39], v[12:13], v[62:63]
    v_cvt_pk_bf16_f32 v48, v32, v36
    buffer_store_dword v48, v68, s[52:55], 0 offen offset:0 sc1
    v_cvt_pk_bf16_f32 v49, v33, v37
    buffer_store_dword v49, v69, s[52:55], 0 offen offset:2560 sc1
    v_cvt_pk_bf16_f32 v50, v34, v38
    buffer_store_dword v50, v70, s[52:55], s11 offen offset:0 sc1
    v_cvt_pk_bf16_f32 v51, v35, v39
    buffer_store_dword v51, v71, s[52:55], s11 offen offset:2560 sc1
L_p2e:
    s_endpgm
L_cb6:
    s_nop 7
    v_pk_fma_f32 v[16:17], v[16:17], v[8:9], v[40:41]
    v_pk_fma_f32 v[18:19], v[18:19], v[12:13], v[42:43]
    v_pk_fma_f32 v[20:21], v[20:21], v[8:9], v[44:45]
    v_pk_fma_f32 v[22:23], v[22:23], v[12:13], v[46:47]
    v_pk_fma_f32 v[24:25], v[24:25], v[8:9], v[48:49]
    v_pk_fma_f32 v[26:27], v[26:27], v[12:13], v[50:51]
    v_pk_fma_f32 v[28:29], v[28:29], v[8:9], v[52:53]
    v_pk_fma_f32 v[30:31], v[30:31], v[12:13], v[54:55]
    v_cvt_pk_bf16_f32 v40, v16, v20
    v_cvt_pk_bf16_f32 v41, v24, v28
    buffer_store_dwordx2 v[40:41], v64, s[52:55], 0 offen offset:0 sc1
    v_cvt_pk_bf16_f32 v42, v17, v21
    v_cvt_pk_bf16_f32 v43, v25, v29
    buffer_store_dwordx2 v[42:43], v65, s[52:55], 0 offen offset:2560 sc1
    v_cvt_pk_bf16_f32 v44, v18, v22
    v_cvt_pk_bf16_f32 v45, v26, v30
    buffer_store_dwordx2 v[44:45], v66, s[52:55], s11 offen offset:0 sc1
    v_cvt_pk_bf16_f32 v46, v19, v23
    v_cvt_pk_bf16_f32 v47, v27, v31
    buffer_store_dwordx2 v[46:47], v67, s[52:55], s11 offen offset:2560 sc1
    s_branch L_p2e
L_exit:
    s_endpgm
.Lcode_end:
.org gated_mix__sliding_local_dilated__moe_arch_mod__prompt_kernel + 33024, 0
.section .rodata,"a"
.p2align 6
.amdhsa_kernel gated_mix__sliding_local_dilated__moe_arch_mod__prompt_kernel
.amdhsa_next_free_vgpr 256
.amdhsa_next_free_sgpr 72
.amdhsa_accum_offset 256
.amdhsa_group_segment_fixed_size 0
.amdhsa_kernarg_size 96
.amdhsa_user_sgpr_count 2
.amdhsa_user_sgpr_kernarg_segment_ptr 1
.amdhsa_system_sgpr_workgroup_id_x 1
.end_amdhsa_kernel
```
